```python
import torch

def _softmax(x, axis=-1):
    return torch.softmax(x, dim=axis)
def _gelu(x):
    return torch.nn.functional.gelu(x, approximate="tanh")
def _silu(x):
    return torch.nn.functional.silu(x)
def _sigmoid(x):
    return torch.sigmoid(x)
def _layernorm(x, axis=-1, eps=1e-5):
    m = x.mean(dim=axis, keepdim=True)
    v = x.var(dim=axis, keepdim=True, unbiased=False)
    return (x - m) / torch.sqrt(v + eps)
def _scatter_add(tgt, idx, src, axis=0):
    return tgt.clone().index_add_(axis, idx, src)
def _segment_sum(src, seg, n):
    out = torch.zeros((n,) + src.shape[1:], dtype=src.dtype)
    return out.index_add_(0, seg, src)
def _pad(x, pw):
    flat = tuple(v for pair in reversed(pw) for v in pair)
    return torch.nn.functional.pad(x, flat)

kernel_name = 'parallel_sum__linear_kernel_hedgehog__glu_gated_reglu__prompt'

def setup_inputs():

    _w = (lambda a: (lambda t: t.to(torch.bfloat16) if t.is_floating_point() else t)(torch.as_tensor(a)))
    def _A_setup():
        B, S, D, H = 1, 2048, 512, 32
        Dh = D // H
        return {
            "x": _w((lambda *s: torch.randn(*s, dtype=torch.bfloat16) * 0.05)(B, S, D)),
            "wqkv": _w((lambda *s: torch.randn(*s, dtype=torch.bfloat16) * 0.2)(D, 3 * D)),
            "w_phi": _w((lambda *s: torch.randn(*s, dtype=torch.bfloat16) * 0.2)(H, Dh, Dh) * (Dh ** -0.5)),
            "wo": _w((lambda *s: torch.randn(*s, dtype=torch.bfloat16) * 0.05)(D, D)),
        }
    _A_in = _A_setup()

    def _B_setup():
        B, S, D, F = 1, 2048, 512, 1792
        return {
            "x": _w((lambda *s: torch.randn(*s, dtype=torch.bfloat16) * 0.05)(B, S, D)),
            "W_gate": _w((lambda *s: torch.randn(*s, dtype=torch.bfloat16) * 0.4)(D, F) * (2.0 / D) ** 0.5),
            "W_up": _w((lambda *s: torch.randn(*s, dtype=torch.bfloat16) * 0.4)(D, F) * (2.0 / D) ** 0.5),
            "W_down": _w((lambda *s: torch.randn(*s, dtype=torch.bfloat16) * 0.4)(F, D) * (1.0 / F) ** 0.5),
        }
    _B_in = _B_setup()

    return {
        "A_x": _A_in["x"],
        "A_wqkv": _A_in["wqkv"],
        "A_w_phi": _A_in["w_phi"],
        "A_wo": _A_in["wo"],
        "B_x": _B_in["x"],
        "B_W_gate": _B_in["W_gate"],
        "B_W_up": _B_in["W_up"],
        "B_W_down": _B_in["W_down"],
    }

def reference(A_x, A_wqkv, A_w_phi, A_wo, B_x, B_W_gate, B_W_up, B_W_down):
    def _A_ref(x, wqkv, w_phi, wo):
        B, S, D = x.shape
        H = 32; Dh = D // H
        qkv = (lambda x, *d: x.permute(*d))((x @ wqkv).reshape(B, S, 3, H, Dh), 2, 0, 3, 1, 4)
        q, k, v = qkv[0], qkv[1], qkv[2]
        pq = torch.einsum("bhsd,hdf->bhsf", q, w_phi)
        pk = torch.einsum("bhsd,hdf->bhsf", k, w_phi)
        phi_q = torch.concatenate([_softmax(pq, axis=-1), _softmax(-pq, axis=-1)], axis=-1)
        phi_k = torch.concatenate([_softmax(pk, axis=-1), _softmax(-pk, axis=-1)], axis=-1)
        kv = torch.einsum("bhsf,bhsd->bhfd", phi_k, v)
        z  = torch.einsum("bhsf->bhf", phi_k)
        num = torch.einsum("bhqf,bhfd->bhqd", phi_q, kv)
        den = torch.einsum("bhqf,bhf->bhq", phi_q, z)[..., None] + 1e-6
        o = num / den
        return (lambda x, *d: x.permute(*d))(o, 0, 2, 1, 3).reshape(B, S, D) @ wo

    def _B_ref(x, W_gate, W_up, W_down):
        gate = torch.einsum("bsd,df->bsf", x, W_gate)
        up = torch.einsum("bsd,df->bsf", x, W_up)
        gate = gate * (lambda x, dt: x.to(dt))(gate > 0, gate.dtype)
        h = gate * up
        return torch.einsum("bsf,fd->bsd", h, W_down)

    x = A_x
    xn = _layernorm(x, axis=-1)
    return x + _A_ref(xn, A_wqkv, A_w_phi, A_wo) + _B_ref(xn, B_W_gate, B_W_up, B_W_down)
```

```asm
; @launch kernel=ln_kernel grid=(512,1,1) block=(256,1,1) lds=0
; @launch kernel=gemm1_kernel grid=(256,1,1) block=(512,1,1) lds=131072
; @launch kernel=gemm2_kernel grid=(256,1,1) block=(512,1,1) lds=131072
.amdgcn_target "amdgcn-amd-amdhsa--gfx950"
.text
.globl ln_kernel
.p2align 8
.type ln_kernel,@function
ln_kernel:
    s_cmp_ge_u32 s2, 512
    s_cbranch_scc1 L0_end
    s_load_dwordx2 s[4:5], s[0:1], 0
    s_load_dwordx2 s[6:7], s[0:1], 80
    v_and_b32 v1, 63, v0
    v_lshrrev_b32 v2, 6, v0
    s_lshl_b32 s3, s2, 2
    v_add_u32 v3, s3, v2
    v_lshlrev_b32 v4, 10, v3
    v_lshl_add_u32 v4, v1, 4, v4
    s_waitcnt lgkmcnt(0)
    global_load_dwordx4 v[8:11], v4, s[4:5]
    s_cmp_ge_u32 s2, 32
    s_cbranch_scc1 L0_nozero
    v_lshlrev_b32 v5, 4, v0
    s_lshl_b32 s8, s2, 12
    s_add_u32 s8, s8, 13631488
    v_add_u32 v5, s8, v5
    v_mov_b32 v12, 0
    v_mov_b32 v13, 0
    v_mov_b32 v14, 0
    v_mov_b32 v15, 0
    global_store_dwordx4 v5, v[12:15], s[6:7]
L0_nozero:
    s_waitcnt vmcnt(0)
    v_lshlrev_b32 v16, 16, v8
    v_and_b32 v17, 0xffff0000, v8
    v_lshlrev_b32 v18, 16, v9
    v_and_b32 v19, 0xffff0000, v9
    v_lshlrev_b32 v20, 16, v10
    v_and_b32 v21, 0xffff0000, v10
    v_lshlrev_b32 v22, 16, v11
    v_and_b32 v23, 0xffff0000, v11
    v_add_f32 v24, v16, v17
    v_add_f32 v24, v24, v18
    v_add_f32 v24, v24, v19
    v_add_f32 v24, v24, v20
    v_add_f32 v24, v24, v21
    v_add_f32 v24, v24, v22
    v_add_f32 v24, v24, v23
    s_nop 1
    v_add_f32_dpp v25, v24, v24 row_ror:8 row_mask:0xf bank_mask:0xf
    v_mov_b32 v24, v25
    s_nop 1
    v_add_f32_dpp v25, v24, v24 row_ror:4 row_mask:0xf bank_mask:0xf
    v_mov_b32 v24, v25
    s_nop 1
    v_add_f32_dpp v25, v24, v24 row_ror:2 row_mask:0xf bank_mask:0xf
    v_mov_b32 v24, v25
    s_nop 1
    v_add_f32_dpp v25, v24, v24 row_ror:1 row_mask:0xf bank_mask:0xf
    v_mov_b32 v24, v25
    v_mov_b32 v25, v24
    s_nop 1
    v_permlane16_swap_b32 v24, v25
    s_nop 0
    v_add_f32 v24, v24, v25
    v_mov_b32 v25, v24
    s_nop 1
    v_permlane32_swap_b32 v24, v25
    s_nop 0
    v_add_f32 v24, v24, v25
    v_mul_f32 v24, 0x3b000000, v24
    v_sub_f32 v26, v16, v24
    v_mul_f32 v27, v26, v26
    v_sub_f32 v26, v17, v24
    v_fmac_f32 v27, v26, v26
    v_sub_f32 v26, v18, v24
    v_fmac_f32 v27, v26, v26
    v_sub_f32 v26, v19, v24
    v_fmac_f32 v27, v26, v26
    v_sub_f32 v26, v20, v24
    v_fmac_f32 v27, v26, v26
    v_sub_f32 v26, v21, v24
    v_fmac_f32 v27, v26, v26
    v_sub_f32 v26, v22, v24
    v_fmac_f32 v27, v26, v26
    v_sub_f32 v26, v23, v24
    v_fmac_f32 v27, v26, v26
    s_nop 1
    v_add_f32_dpp v25, v27, v27 row_ror:8 row_mask:0xf bank_mask:0xf
    v_mov_b32 v27, v25
    s_nop 1
    v_add_f32_dpp v25, v27, v27 row_ror:4 row_mask:0xf bank_mask:0xf
    v_mov_b32 v27, v25
    s_nop 1
    v_add_f32_dpp v25, v27, v27 row_ror:2 row_mask:0xf bank_mask:0xf
    v_mov_b32 v27, v25
    s_nop 1
    v_add_f32_dpp v25, v27, v27 row_ror:1 row_mask:0xf bank_mask:0xf
    v_mov_b32 v27, v25
    v_mov_b32 v25, v27
    s_nop 1
    v_permlane16_swap_b32 v27, v25
    s_nop 0
    v_add_f32 v27, v27, v25
    v_mov_b32 v25, v27
    s_nop 1
    v_permlane32_swap_b32 v27, v25
    s_nop 0
    v_add_f32 v27, v27, v25
    v_mul_f32 v27, 0x3b000000, v27
    v_cvt_pk_bf16_f32 v28, v24, v27
    v_lshlrev_b32 v24, 16, v28
    v_and_b32 v27, 0xffff0000, v28
    v_add_f32 v27, 0x3727c5ac, v27
    v_cvt_pk_bf16_f32 v28, v27, v27
    v_and_b32 v27, 0xffff0000, v28
    v_sqrt_f32 v27, v27
    s_nop 0
    v_cvt_pk_bf16_f32 v28, v27, v27
    v_and_b32 v27, 0xffff0000, v28
    v_rcp_f32 v27, v27
    s_nop 0
    v_sub_f32 v16, v16, v24
    v_sub_f32 v17, v17, v24
    v_cvt_pk_bf16_f32 v28, v16, v17
    v_lshlrev_b32 v16, 16, v28
    v_and_b32 v17, 0xffff0000, v28
    v_mul_f32 v16, v16, v27
    v_mul_f32 v17, v17, v27
    v_cvt_pk_bf16_f32 v8, v16, v17
    v_sub_f32 v18, v18, v24
    v_sub_f32 v19, v19, v24
    v_cvt_pk_bf16_f32 v28, v18, v19
    v_lshlrev_b32 v18, 16, v28
    v_and_b32 v19, 0xffff0000, v28
    v_mul_f32 v18, v18, v27
    v_mul_f32 v19, v19, v27
    v_cvt_pk_bf16_f32 v9, v18, v19
    v_sub_f32 v20, v20, v24
    v_sub_f32 v21, v21, v24
    v_cvt_pk_bf16_f32 v28, v20, v21
    v_lshlrev_b32 v20, 16, v28
    v_and_b32 v21, 0xffff0000, v28
    v_mul_f32 v20, v20, v27
    v_mul_f32 v21, v21, v27
    v_cvt_pk_bf16_f32 v10, v20, v21
    v_sub_f32 v22, v22, v24
    v_sub_f32 v23, v23, v24
    v_cvt_pk_bf16_f32 v28, v22, v23
    v_lshlrev_b32 v22, 16, v28
    v_and_b32 v23, 0xffff0000, v28
    v_mul_f32 v22, v22, v27
    v_mul_f32 v23, v23, v27
    v_cvt_pk_bf16_f32 v11, v22, v23
    v_lshrrev_b32 v12, 4, v3
    v_lshlrev_b32 v12, 4, v12
    v_lshrrev_b32 v13, 2, v1
    v_add_u32 v12, v12, v13
    v_lshlrev_b32 v12, 6, v12
    v_and_b32 v13, 15, v3
    v_add_u32 v12, v12, v13
    v_and_b32 v13, 1, v1
    v_lshlrev_b32 v13, 5, v13
    v_add_u32 v12, v12, v13
    v_lshlrev_b32 v12, 4, v12
    v_bfe_u32 v13, v1, 1, 1
    v_lshl_add_u32 v12, v13, 3, v12
    global_store_dwordx2 v12, v[8:9], s[6:7]
    global_store_dwordx2 v12, v[10:11], s[6:7] offset:256
L0_end:
    s_endpgm
.globl gemm1_kernel
.p2align 8
.type gemm1_kernel,@function
gemm1_kernel:
    s_cmp_ge_u32 s2, 256
    s_cbranch_scc1 L1_end
    s_load_dwordx4 s[4:7], s[0:1], 8
    s_load_dwordx4 s[8:11], s[0:1], 40
    s_load_dwordx2 s[12:13], s[0:1], 80
    v_and_b32 v1, 63, v0
    v_lshrrev_b32 v6, 6, v0
    s_nop 0
    v_readfirstlane_b32 s16, v6
    s_lshr_b32 s14, s2, 4
    s_and_b32 s15, s2, 15
    s_and_b32 s17, s16, 3
    s_lshr_b32 s18, s16, 2
    s_mov_b32 s19, s15
    s_mov_b32 s20, 0
    s_mov_b32 s30, 0
    v_bfe_u32 v6, v1, 1, 2
    v_bfe_u32 v7, v1, 4, 2
    v_xor_b32 v12, v6, v7
    v_lshrrev_b32 v13, 3, v1
    s_lshl_b32 s31, s16, 6
    v_add_u32 v13, s31, v13
    v_and_b32 v6, 1, v12
    v_lshlrev_b32 v14, 5, v6
    v_and_b32 v6, 1, v1
    v_lshl_add_u32 v14, v6, 4, v14
    v_lshrrev_b32 v6, 4, v1
    v_lshlrev_b32 v15, 7, v6
    v_and_b32 v7, 15, v1
    v_lshl_add_u32 v15, v7, 1, v15
    v_bfe_u32 v7, v1, 2, 2
    v_lshl_add_u32 v8, v6, 2, v7
    v_lshlrev_b32 v8, 7, v8
    v_and_b32 v9, 3, v1
    v_lshl_add_u32 v8, v9, 3, v8
    v_lshrrev_b32 v9, 1, v7
    v_lshl_add_u32 v9, v6, 1, v9
    v_and_b32 v9, 3, v9
    v_xor_b32 v10, s18, v9
    v_lshl_add_u32 v4, v10, 5, v8
    v_xor_b32 v10, 2, v10
    v_lshl_add_u32 v5, v10, 5, v8
    s_waitcnt lgkmcnt(0)
    s_lshl_b32 s31, s14, 3
    s_lshl_b32 s32, s17, 1
    s_add_u32 s31, s31, s32
    s_lshl_b32 s31, s31, 14
    s_add_u32 s32, s12, s31
    s_addc_u32 s33, s13, 0
    v_lshlrev_b32 v6, 4, v1
    global_load_dwordx4 v[128:131], v6, s[32:33]
    s_add_u32 s32, s32, 1024
    s_addc_u32 s33, s33, 0
    global_load_dwordx4 v[132:135], v6, s[32:33]
    s_add_u32 s32, s32, 1024
    s_addc_u32 s33, s33, 0
    global_load_dwordx4 v[136:139], v6, s[32:33]
    s_add_u32 s32, s32, 1024
    s_addc_u32 s33, s33, 0
    global_load_dwordx4 v[140:143], v6, s[32:33]
    s_add_u32 s32, s32, 1024
    s_addc_u32 s33, s33, 0
    global_load_dwordx4 v[144:147], v6, s[32:33]
    s_add_u32 s32, s32, 1024
    s_addc_u32 s33, s33, 0
    global_load_dwordx4 v[148:151], v6, s[32:33]
    s_add_u32 s32, s32, 1024
    s_addc_u32 s33, s33, 0
    global_load_dwordx4 v[152:155], v6, s[32:33]
    s_add_u32 s32, s32, 1024
    s_addc_u32 s33, s33, 0
    global_load_dwordx4 v[156:159], v6, s[32:33]
    s_add_u32 s32, s32, 1024
    s_addc_u32 s33, s33, 0
    global_load_dwordx4 v[160:163], v6, s[32:33]
    s_add_u32 s32, s32, 1024
    s_addc_u32 s33, s33, 0
    global_load_dwordx4 v[164:167], v6, s[32:33]
    s_add_u32 s32, s32, 1024
    s_addc_u32 s33, s33, 0
    global_load_dwordx4 v[168:171], v6, s[32:33]
    s_add_u32 s32, s32, 1024
    s_addc_u32 s33, s33, 0
    global_load_dwordx4 v[172:175], v6, s[32:33]
    s_add_u32 s32, s32, 1024
    s_addc_u32 s33, s33, 0
    global_load_dwordx4 v[176:179], v6, s[32:33]
    s_add_u32 s32, s32, 1024
    s_addc_u32 s33, s33, 0
    global_load_dwordx4 v[180:183], v6, s[32:33]
    s_add_u32 s32, s32, 1024
    s_addc_u32 s33, s33, 0
    global_load_dwordx4 v[184:187], v6, s[32:33]
    s_add_u32 s32, s32, 1024
    s_addc_u32 s33, s33, 0
    global_load_dwordx4 v[188:191], v6, s[32:33]
    s_add_u32 s32, s32, 1024
    s_addc_u32 s33, s33, 0
    global_load_dwordx4 v[192:195], v6, s[32:33]
    s_add_u32 s32, s32, 1024
    s_addc_u32 s33, s33, 0
    global_load_dwordx4 v[196:199], v6, s[32:33]
    s_add_u32 s32, s32, 1024
    s_addc_u32 s33, s33, 0
    global_load_dwordx4 v[200:203], v6, s[32:33]
    s_add_u32 s32, s32, 1024
    s_addc_u32 s33, s33, 0
    global_load_dwordx4 v[204:207], v6, s[32:33]
    s_add_u32 s32, s32, 1024
    s_addc_u32 s33, s33, 0
    global_load_dwordx4 v[208:211], v6, s[32:33]
    s_add_u32 s32, s32, 1024
    s_addc_u32 s33, s33, 0
    global_load_dwordx4 v[212:215], v6, s[32:33]
    s_add_u32 s32, s32, 1024
    s_addc_u32 s33, s33, 0
    global_load_dwordx4 v[216:219], v6, s[32:33]
    s_add_u32 s32, s32, 1024
    s_addc_u32 s33, s33, 0
    global_load_dwordx4 v[220:223], v6, s[32:33]
    s_add_u32 s32, s32, 1024
    s_addc_u32 s33, s33, 0
    global_load_dwordx4 v[224:227], v6, s[32:33]
    s_add_u32 s32, s32, 1024
    s_addc_u32 s33, s33, 0
    global_load_dwordx4 v[228:231], v6, s[32:33]
    s_add_u32 s32, s32, 1024
    s_addc_u32 s33, s33, 0
    global_load_dwordx4 v[232:235], v6, s[32:33]
    s_add_u32 s32, s32, 1024
    s_addc_u32 s33, s33, 0
    global_load_dwordx4 v[236:239], v6, s[32:33]
    s_add_u32 s32, s32, 1024
    s_addc_u32 s33, s33, 0
    global_load_dwordx4 v[240:243], v6, s[32:33]
    s_add_u32 s32, s32, 1024
    s_addc_u32 s33, s33, 0
    global_load_dwordx4 v[244:247], v6, s[32:33]
    s_add_u32 s32, s32, 1024
    s_addc_u32 s33, s33, 0
    global_load_dwordx4 v[248:251], v6, s[32:33]
    s_add_u32 s32, s32, 1024
    s_addc_u32 s33, s33, 0
    global_load_dwordx4 v[252:255], v6, s[32:33]
    s_add_u32 s32, s32, 1024
    s_addc_u32 s33, s33, 0
    s_cmp_ge_u32 s19, 24
    s_cbranch_scc1 L1_dma_mlp_pro
    s_cmp_ge_u32 s19, 8
    s_cbranch_scc1 L1_dma_kv_pro
    s_lshl_b32 s31, s19, 7
    s_add_u32 s24, s4, s31
    s_addc_u32 s25, s5, 0
    s_add_u32 s26, s24, 64
    s_addc_u32 s27, s25, 0
    s_movk_i32 s28, 3072
    s_branch L1_dma_go_pro
L1_dma_kv_pro:
    s_sub_u32 s31, s19, 8
    s_lshl_b32 s31, s31, 6
    s_add_u32 s31, s31, 1024
    s_add_u32 s24, s4, s31
    s_addc_u32 s25, s5, 0
    s_add_u32 s26, s24, 1024
    s_addc_u32 s27, s25, 0
    s_movk_i32 s28, 3072
    s_branch L1_dma_go_pro
L1_dma_mlp_pro:
    s_sub_u32 s31, s19, 24
    s_lshl_b32 s31, s31, 6
    s_add_u32 s24, s8, s31
    s_addc_u32 s25, s9, 0
    s_add_u32 s26, s10, s31
    s_addc_u32 s27, s11, 0
    s_movk_i32 s28, 3584
L1_dma_go_pro:
    s_lshl_b32 s29, s28, 3
    v_cmp_le_u32 vcc, 2, v12
    v_mov_b32 v6, s24
    v_mov_b32 v7, s26
    v_cndmask_b32 v2, v6, v7, vcc
    v_mov_b32 v6, s25
    v_mov_b32 v7, s27
    v_cndmask_b32 v3, v6, v7, vcc
    v_mul_lo_u32 v6, v13, s28
    v_add_u32 v6, v6, v14
    v_add_co_u32 v2, vcc, v2, v6
    v_addc_co_u32 v3, vcc, 0, v3, vcc
    s_lshl_b32 s31, s16, 13
    s_add_u32 s31, s31, s30
    v_lshlrev_b32 v11, 4, v1
    v_add_u32 v11, s31, v11
    global_load_dwordx4 v[48:51], v[2:3], off
    v_add_co_u32 v2, vcc, s29, v2
    v_addc_co_u32 v3, vcc, 0, v3, vcc
    global_load_dwordx4 v[52:55], v[2:3], off
    v_add_co_u32 v2, vcc, s29, v2
    v_addc_co_u32 v3, vcc, 0, v3, vcc
    global_load_dwordx4 v[56:59], v[2:3], off
    v_add_co_u32 v2, vcc, s29, v2
    v_addc_co_u32 v3, vcc, 0, v3, vcc
    global_load_dwordx4 v[60:63], v[2:3], off
    v_add_co_u32 v2, vcc, s29, v2
    v_addc_co_u32 v3, vcc, 0, v3, vcc
    global_load_dwordx4 v[64:67], v[2:3], off
    v_add_co_u32 v2, vcc, s29, v2
    v_addc_co_u32 v3, vcc, 0, v3, vcc
    global_load_dwordx4 v[68:71], v[2:3], off
    v_add_co_u32 v2, vcc, s29, v2
    v_addc_co_u32 v3, vcc, 0, v3, vcc
    global_load_dwordx4 v[72:75], v[2:3], off
    v_add_co_u32 v2, vcc, s29, v2
    v_addc_co_u32 v3, vcc, 0, v3, vcc
    global_load_dwordx4 v[76:79], v[2:3], off
    s_waitcnt vmcnt(0)
    ds_write_b128 v11, v[48:51] offset:0
    ds_write_b128 v11, v[52:55] offset:1024
    ds_write_b128 v11, v[56:59] offset:2048
    ds_write_b128 v11, v[60:63] offset:3072
    ds_write_b128 v11, v[64:67] offset:4096
    ds_write_b128 v11, v[68:71] offset:5120
    ds_write_b128 v11, v[72:75] offset:6144
    ds_write_b128 v11, v[76:79] offset:7168
    s_waitcnt lgkmcnt(0)
L1_loop:
    s_barrier
    s_cmp_ge_u32 s20, 4
    s_cbranch_scc1 L1_nodma
    s_add_u32 s19, s19, 16
    s_cmp_ge_u32 s19, 24
    s_cbranch_scc1 L1_dma_mlp_loop
    s_cmp_ge_u32 s19, 8
    s_cbranch_scc1 L1_dma_kv_loop
    s_lshl_b32 s31, s19, 7
    s_add_u32 s24, s4, s31
    s_addc_u32 s25, s5, 0
    s_add_u32 s26, s24, 64
    s_addc_u32 s27, s25, 0
    s_movk_i32 s28, 3072
    s_branch L1_dma_go_loop
L1_dma_kv_loop:
    s_sub_u32 s31, s19, 8
    s_lshl_b32 s31, s31, 6
    s_add_u32 s31, s31, 1024
    s_add_u32 s24, s4, s31
    s_addc_u32 s25, s5, 0
    s_add_u32 s26, s24, 1024
    s_addc_u32 s27, s25, 0
    s_movk_i32 s28, 3072
    s_branch L1_dma_go_loop
L1_dma_mlp_loop:
    s_sub_u32 s31, s19, 24
    s_lshl_b32 s31, s31, 6
    s_add_u32 s24, s8, s31
    s_addc_u32 s25, s9, 0
    s_add_u32 s26, s10, s31
    s_addc_u32 s27, s11, 0
    s_movk_i32 s28, 3584
L1_dma_go_loop:
    s_lshl_b32 s29, s28, 3
    v_cmp_le_u32 vcc, 2, v12
    v_mov_b32 v6, s24
    v_mov_b32 v7, s26
    v_cndmask_b32 v2, v6, v7, vcc
    v_mov_b32 v6, s25
    v_mov_b32 v7, s27
    v_cndmask_b32 v3, v6, v7, vcc
    v_mul_lo_u32 v6, v13, s28
    v_add_u32 v6, v6, v14
    v_add_co_u32 v2, vcc, v2, v6
    v_addc_co_u32 v3, vcc, 0, v3, vcc
    s_sub_u32 s19, s19, 16
    s_xor_b32 s34, s30, 0x10000
    s_lshl_b32 s31, s16, 13
    s_add_u32 s31, s31, s34
    v_lshlrev_b32 v11, 4, v1
    v_add_u32 v11, s31, v11
    global_load_dwordx4 v[48:51], v[2:3], off
    v_add_co_u32 v2, vcc, s29, v2
    v_addc_co_u32 v3, vcc, 0, v3, vcc
    global_load_dwordx4 v[52:55], v[2:3], off
    v_add_co_u32 v2, vcc, s29, v2
    v_addc_co_u32 v3, vcc, 0, v3, vcc
    global_load_dwordx4 v[56:59], v[2:3], off
    v_add_co_u32 v2, vcc, s29, v2
    v_addc_co_u32 v3, vcc, 0, v3, vcc
    global_load_dwordx4 v[60:63], v[2:3], off
    v_add_co_u32 v2, vcc, s29, v2
    v_addc_co_u32 v3, vcc, 0, v3, vcc
    global_load_dwordx4 v[64:67], v[2:3], off
    v_add_co_u32 v2, vcc, s29, v2
    v_addc_co_u32 v3, vcc, 0, v3, vcc
    global_load_dwordx4 v[68:71], v[2:3], off
    v_add_co_u32 v2, vcc, s29, v2
    v_addc_co_u32 v3, vcc, 0, v3, vcc
    global_load_dwordx4 v[72:75], v[2:3], off
    v_add_co_u32 v2, vcc, s29, v2
    v_addc_co_u32 v3, vcc, 0, v3, vcc
    global_load_dwordx4 v[76:79], v[2:3], off
L1_nodma:
    s_cmp_ge_u32 s19, 8
    s_cbranch_scc0 L1_main_std
    s_cmp_ge_u32 s19, 24
    s_cbranch_scc1 L1_main_std
    s_sub_u32 s21, s19, 8
    s_lshl_b32 s21, s21, 1
    s_add_u32 s21, s21, s18
    s_lshl_b32 s31, s21, 9
    s_add_u32 s32, s6, s31
    s_addc_u32 s33, s7, 0
    global_load_ushort v120, v15, s[32:33] offset:0
    global_load_ushort v121, v15, s[32:33] offset:32
    global_load_ushort v122, v15, s[32:33] offset:64
    global_load_ushort v123, v15, s[32:33] offset:96
    v_mov_b32 v16, 0
    v_mov_b32 v17, 0
    v_mov_b32 v18, 0
    v_mov_b32 v19, 0
    v_mov_b32 v20, 0
    v_mov_b32 v21, 0
    v_mov_b32 v22, 0
    v_mov_b32 v23, 0
    v_mov_b32 v24, 0
    v_mov_b32 v25, 0
    v_mov_b32 v26, 0
    v_mov_b32 v27, 0
    v_mov_b32 v28, 0
    v_mov_b32 v29, 0
    v_mov_b32 v30, 0
    v_mov_b32 v31, 0
    ds_read_b64_tr_b16 v[32:33], v4 offset:0
    ds_read_b64_tr_b16 v[34:35], v4 offset:2048
    ds_read_b64_tr_b16 v[36:37], v5 offset:0
    ds_read_b64_tr_b16 v[38:39], v5 offset:2048
    ds_read_b64_tr_b16 v[40:41], v4 offset:4096
    ds_read_b64_tr_b16 v[42:43], v4 offset:6144
    ds_read_b64_tr_b16 v[44:45], v5 offset:4096
    ds_read_b64_tr_b16 v[46:47], v5 offset:6144
    s_waitcnt lgkmcnt(4)
    v_mfma_f32_16x16x32_bf16 v[16:19], v[32:35], v[128:131], v[16:19]
    v_mfma_f32_16x16x32_bf16 v[20:23], v[128:131], v[36:39], v[20:23]
    v_mfma_f32_16x16x32_bf16 v[24:27], v[32:35], v[192:195], v[24:27]
    v_mfma_f32_16x16x32_bf16 v[28:31], v[192:195], v[36:39], v[28:31]
    ds_read_b64_tr_b16 v[32:33], v4 offset:8192
    ds_read_b64_tr_b16 v[34:35], v4 offset:10240
    ds_read_b64_tr_b16 v[36:37], v5 offset:8192
    ds_read_b64_tr_b16 v[38:39], v5 offset:10240
    s_waitcnt lgkmcnt(4)
    v_mfma_f32_16x16x32_bf16 v[16:19], v[40:43], v[132:135], v[16:19]
    v_mfma_f32_16x16x32_bf16 v[20:23], v[132:135], v[44:47], v[20:23]
    v_mfma_f32_16x16x32_bf16 v[24:27], v[40:43], v[196:199], v[24:27]
    v_mfma_f32_16x16x32_bf16 v[28:31], v[196:199], v[44:47], v[28:31]
    ds_read_b64_tr_b16 v[40:41], v4 offset:12288
    ds_read_b64_tr_b16 v[42:43], v4 offset:14336
    ds_read_b64_tr_b16 v[44:45], v5 offset:12288
    ds_read_b64_tr_b16 v[46:47], v5 offset:14336
    s_waitcnt lgkmcnt(4)
    v_mfma_f32_16x16x32_bf16 v[16:19], v[32:35], v[136:139], v[16:19]
    v_mfma_f32_16x16x32_bf16 v[20:23], v[136:139], v[36:39], v[20:23]
    v_mfma_f32_16x16x32_bf16 v[24:27], v[32:35], v[200:203], v[24:27]
    v_mfma_f32_16x16x32_bf16 v[28:31], v[200:203], v[36:39], v[28:31]
    ds_read_b64_tr_b16 v[32:33], v4 offset:16384
    ds_read_b64_tr_b16 v[34:35], v4 offset:18432
    ds_read_b64_tr_b16 v[36:37], v5 offset:16384
    ds_read_b64_tr_b16 v[38:39], v5 offset:18432
    s_waitcnt lgkmcnt(4)
    v_mfma_f32_16x16x32_bf16 v[16:19], v[40:43], v[140:143], v[16:19]
    v_mfma_f32_16x16x32_bf16 v[20:23], v[140:143], v[44:47], v[20:23]
    v_mfma_f32_16x16x32_bf16 v[24:27], v[40:43], v[204:207], v[24:27]
    v_mfma_f32_16x16x32_bf16 v[28:31], v[204:207], v[44:47], v[28:31]
    ds_read_b64_tr_b16 v[40:41], v4 offset:20480
    ds_read_b64_tr_b16 v[42:43], v4 offset:22528
    ds_read_b64_tr_b16 v[44:45], v5 offset:20480
    ds_read_b64_tr_b16 v[46:47], v5 offset:22528
    s_waitcnt lgkmcnt(4)
    v_mfma_f32_16x16x32_bf16 v[16:19], v[32:35], v[144:147], v[16:19]
    v_mfma_f32_16x16x32_bf16 v[20:23], v[144:147], v[36:39], v[20:23]
    v_mfma_f32_16x16x32_bf16 v[24:27], v[32:35], v[208:211], v[24:27]
    v_mfma_f32_16x16x32_bf16 v[28:31], v[208:211], v[36:39], v[28:31]
    ds_read_b64_tr_b16 v[32:33], v4 offset:24576
    ds_read_b64_tr_b16 v[34:35], v4 offset:26624
    ds_read_b64_tr_b16 v[36:37], v5 offset:24576
    ds_read_b64_tr_b16 v[38:39], v5 offset:26624
    s_waitcnt lgkmcnt(4)
    v_mfma_f32_16x16x32_bf16 v[16:19], v[40:43], v[148:151], v[16:19]
    v_mfma_f32_16x16x32_bf16 v[20:23], v[148:151], v[44:47], v[20:23]
    v_mfma_f32_16x16x32_bf16 v[24:27], v[40:43], v[212:215], v[24:27]
    v_mfma_f32_16x16x32_bf16 v[28:31], v[212:215], v[44:47], v[28:31]
    ds_read_b64_tr_b16 v[40:41], v4 offset:28672
    ds_read_b64_tr_b16 v[42:43], v4 offset:30720
    ds_read_b64_tr_b16 v[44:45], v5 offset:28672
    ds_read_b64_tr_b16 v[46:47], v5 offset:30720
    s_waitcnt lgkmcnt(4)
    v_mfma_f32_16x16x32_bf16 v[16:19], v[32:35], v[152:155], v[16:19]
    v_mfma_f32_16x16x32_bf16 v[20:23], v[152:155], v[36:39], v[20:23]
    v_mfma_f32_16x16x32_bf16 v[24:27], v[32:35], v[216:219], v[24:27]
    v_mfma_f32_16x16x32_bf16 v[28:31], v[216:219], v[36:39], v[28:31]
    ds_read_b64_tr_b16 v[32:33], v4 offset:32768
    ds_read_b64_tr_b16 v[34:35], v4 offset:34816
    ds_read_b64_tr_b16 v[36:37], v5 offset:32768
    ds_read_b64_tr_b16 v[38:39], v5 offset:34816
    s_waitcnt lgkmcnt(4)
    v_mfma_f32_16x16x32_bf16 v[16:19], v[40:43], v[156:159], v[16:19]
    v_mfma_f32_16x16x32_bf16 v[20:23], v[156:159], v[44:47], v[20:23]
    v_mfma_f32_16x16x32_bf16 v[24:27], v[40:43], v[220:223], v[24:27]
    v_mfma_f32_16x16x32_bf16 v[28:31], v[220:223], v[44:47], v[28:31]
    ds_read_b64_tr_b16 v[40:41], v4 offset:36864
    ds_read_b64_tr_b16 v[42:43], v4 offset:38912
    ds_read_b64_tr_b16 v[44:45], v5 offset:36864
    ds_read_b64_tr_b16 v[46:47], v5 offset:38912
    s_waitcnt lgkmcnt(4)
    v_mfma_f32_16x16x32_bf16 v[16:19], v[32:35], v[160:163], v[16:19]
    v_mfma_f32_16x16x32_bf16 v[20:23], v[160:163], v[36:39], v[20:23]
    v_mfma_f32_16x16x32_bf16 v[24:27], v[32:35], v[224:227], v[24:27]
    v_mfma_f32_16x16x32_bf16 v[28:31], v[224:227], v[36:39], v[28:31]
    ds_read_b64_tr_b16 v[32:33], v4 offset:40960
    ds_read_b64_tr_b16 v[34:35], v4 offset:43008
    ds_read_b64_tr_b16 v[36:37], v5 offset:40960
    ds_read_b64_tr_b16 v[38:39], v5 offset:43008
    s_waitcnt lgkmcnt(4)
    v_mfma_f32_16x16x32_bf16 v[16:19], v[40:43], v[164:167], v[16:19]
    v_mfma_f32_16x16x32_bf16 v[20:23], v[164:167], v[44:47], v[20:23]
    v_mfma_f32_16x16x32_bf16 v[24:27], v[40:43], v[228:231], v[24:27]
    v_mfma_f32_16x16x32_bf16 v[28:31], v[228:231], v[44:47], v[28:31]
    ds_read_b64_tr_b16 v[40:41], v4 offset:45056
    ds_read_b64_tr_b16 v[42:43], v4 offset:47104
    ds_read_b64_tr_b16 v[44:45], v5 offset:45056
    ds_read_b64_tr_b16 v[46:47], v5 offset:47104
    s_waitcnt lgkmcnt(4)
    v_mfma_f32_16x16x32_bf16 v[16:19], v[32:35], v[168:171], v[16:19]
    v_mfma_f32_16x16x32_bf16 v[20:23], v[168:171], v[36:39], v[20:23]
    v_mfma_f32_16x16x32_bf16 v[24:27], v[32:35], v[232:235], v[24:27]
    v_mfma_f32_16x16x32_bf16 v[28:31], v[232:235], v[36:39], v[28:31]
    ds_read_b64_tr_b16 v[32:33], v4 offset:49152
    ds_read_b64_tr_b16 v[34:35], v4 offset:51200
    ds_read_b64_tr_b16 v[36:37], v5 offset:49152
    ds_read_b64_tr_b16 v[38:39], v5 offset:51200
    s_waitcnt lgkmcnt(4)
    v_mfma_f32_16x16x32_bf16 v[16:19], v[40:43], v[172:175], v[16:19]
    v_mfma_f32_16x16x32_bf16 v[20:23], v[172:175], v[44:47], v[20:23]
    v_mfma_f32_16x16x32_bf16 v[24:27], v[40:43], v[236:239], v[24:27]
    v_mfma_f32_16x16x32_bf16 v[28:31], v[236:239], v[44:47], v[28:31]
    ds_read_b64_tr_b16 v[40:41], v4 offset:53248
    ds_read_b64_tr_b16 v[42:43], v4 offset:55296
    ds_read_b64_tr_b16 v[44:45], v5 offset:53248
    ds_read_b64_tr_b16 v[46:47], v5 offset:55296
    s_waitcnt lgkmcnt(4)
    v_mfma_f32_16x16x32_bf16 v[16:19], v[32:35], v[176:179], v[16:19]
    v_mfma_f32_16x16x32_bf16 v[20:23], v[176:179], v[36:39], v[20:23]
    v_mfma_f32_16x16x32_bf16 v[24:27], v[32:35], v[240:243], v[24:27]
    v_mfma_f32_16x16x32_bf16 v[28:31], v[240:243], v[36:39], v[28:31]
    ds_read_b64_tr_b16 v[32:33], v4 offset:57344
    ds_read_b64_tr_b16 v[34:35], v4 offset:59392
    ds_read_b64_tr_b16 v[36:37], v5 offset:57344
    ds_read_b64_tr_b16 v[38:39], v5 offset:59392
    s_waitcnt lgkmcnt(4)
    v_mfma_f32_16x16x32_bf16 v[16:19], v[40:43], v[180:183], v[16:19]
    v_mfma_f32_16x16x32_bf16 v[20:23], v[180:183], v[44:47], v[20:23]
    v_mfma_f32_16x16x32_bf16 v[24:27], v[40:43], v[244:247], v[24:27]
    v_mfma_f32_16x16x32_bf16 v[28:31], v[244:247], v[44:47], v[28:31]
    ds_read_b64_tr_b16 v[40:41], v4 offset:61440
    ds_read_b64_tr_b16 v[42:43], v4 offset:63488
    ds_read_b64_tr_b16 v[44:45], v5 offset:61440
    ds_read_b64_tr_b16 v[46:47], v5 offset:63488
    s_waitcnt lgkmcnt(4)
    v_mfma_f32_16x16x32_bf16 v[16:19], v[32:35], v[184:187], v[16:19]
    v_mfma_f32_16x16x32_bf16 v[20:23], v[184:187], v[36:39], v[20:23]
    v_mfma_f32_16x16x32_bf16 v[24:27], v[32:35], v[248:251], v[24:27]
    v_mfma_f32_16x16x32_bf16 v[28:31], v[248:251], v[36:39], v[28:31]
    s_waitcnt lgkmcnt(0)
    v_mfma_f32_16x16x32_bf16 v[16:19], v[40:43], v[188:191], v[16:19]
    v_mfma_f32_16x16x32_bf16 v[20:23], v[188:191], v[44:47], v[20:23]
    v_mfma_f32_16x16x32_bf16 v[24:27], v[40:43], v[252:255], v[24:27]
    v_mfma_f32_16x16x32_bf16 v[28:31], v[252:255], v[44:47], v[28:31]
    s_waitcnt vmcnt(0)
    s_cmp_ge_u32 s20, 4
    s_cbranch_scc1 L1_nofl_1
    ds_write_b128 v11, v[48:51] offset:0
    ds_write_b128 v11, v[52:55] offset:1024
    ds_write_b128 v11, v[56:59] offset:2048
    ds_write_b128 v11, v[60:63] offset:3072
    ds_write_b128 v11, v[64:67] offset:4096
    ds_write_b128 v11, v[68:71] offset:5120
    ds_write_b128 v11, v[72:75] offset:6144
    ds_write_b128 v11, v[76:79] offset:7168
    s_waitcnt lgkmcnt(0)
L1_nofl_1:
    s_nop 9
    s_sub_u32 s21, s19, 8
    s_lshl_b32 s21, s21, 1
    s_add_u32 s21, s21, s18
    v_lshl_or_b32 v52, v121, 16, v120
    v_lshl_or_b32 v53, v123, 16, v122
    v_cvt_pk_bf16_f32 v54, v16, v17
    v_cvt_pk_bf16_f32 v55, v18, v19
    v_mov_b32 v56, 0
    v_mov_b32 v57, 0
    v_mov_b32 v58, 0
    v_mov_b32 v59, 0
    s_nop 1
    v_mfma_f32_16x16x16_bf16 v[56:59], v[54:55], v[52:53], v[56:59]
    s_nop 9
    v_cvt_pk_bf16_f32 v60, v56, v57
    v_cvt_pk_bf16_f32 v61, v58, v59
    v_lshlrev_b32 v56, 16, v60
    v_and_b32 v57, 0xffff0000, v60
    v_lshlrev_b32 v58, 16, v61
    v_and_b32 v59, 0xffff0000, v61
    v_mov_b32 v64, v56
    v_mov_b32 v68, v56
    v_mov_b32 v65, v57
    v_mov_b32 v69, v57
    v_mov_b32 v66, v58
    v_mov_b32 v70, v58
    v_mov_b32 v67, v59
    v_mov_b32 v71, v59
    s_nop 0
    v_max_f32_dpp v72, v64, v64 row_ror:8 row_mask:0xf bank_mask:0xf
    v_min_f32_dpp v76, v68, v68 row_ror:8 row_mask:0xf bank_mask:0xf
    v_max_f32_dpp v73, v65, v65 row_ror:8 row_mask:0xf bank_mask:0xf
    v_min_f32_dpp v77, v69, v69 row_ror:8 row_mask:0xf bank_mask:0xf
    v_max_f32_dpp v74, v66, v66 row_ror:8 row_mask:0xf bank_mask:0xf
    v_min_f32_dpp v78, v70, v70 row_ror:8 row_mask:0xf bank_mask:0xf
    v_max_f32_dpp v75, v67, v67 row_ror:8 row_mask:0xf bank_mask:0xf
    v_min_f32_dpp v79, v71, v71 row_ror:8 row_mask:0xf bank_mask:0xf
    v_mov_b32 v64, v72
    v_mov_b32 v68, v76
    v_mov_b32 v65, v73
    v_mov_b32 v69, v77
    v_mov_b32 v66, v74
    v_mov_b32 v70, v78
    v_mov_b32 v67, v75
    v_mov_b32 v71, v79
    s_nop 0
    v_max_f32_dpp v72, v64, v64 row_ror:4 row_mask:0xf bank_mask:0xf
    v_min_f32_dpp v76, v68, v68 row_ror:4 row_mask:0xf bank_mask:0xf
    v_max_f32_dpp v73, v65, v65 row_ror:4 row_mask:0xf bank_mask:0xf
    v_min_f32_dpp v77, v69, v69 row_ror:4 row_mask:0xf bank_mask:0xf
    v_max_f32_dpp v74, v66, v66 row_ror:4 row_mask:0xf bank_mask:0xf
    v_min_f32_dpp v78, v70, v70 row_ror:4 row_mask:0xf bank_mask:0xf
    v_max_f32_dpp v75, v67, v67 row_ror:4 row_mask:0xf bank_mask:0xf
    v_min_f32_dpp v79, v71, v71 row_ror:4 row_mask:0xf bank_mask:0xf
    v_mov_b32 v64, v72
    v_mov_b32 v68, v76
    v_mov_b32 v65, v73
    v_mov_b32 v69, v77
    v_mov_b32 v66, v74
    v_mov_b32 v70, v78
    v_mov_b32 v67, v75
    v_mov_b32 v71, v79
    s_nop 0
    v_max_f32_dpp v72, v64, v64 row_ror:2 row_mask:0xf bank_mask:0xf
    v_min_f32_dpp v76, v68, v68 row_ror:2 row_mask:0xf bank_mask:0xf
    v_max_f32_dpp v73, v65, v65 row_ror:2 row_mask:0xf bank_mask:0xf
    v_min_f32_dpp v77, v69, v69 row_ror:2 row_mask:0xf bank_mask:0xf
    v_max_f32_dpp v74, v66, v66 row_ror:2 row_mask:0xf bank_mask:0xf
    v_min_f32_dpp v78, v70, v70 row_ror:2 row_mask:0xf bank_mask:0xf
    v_max_f32_dpp v75, v67, v67 row_ror:2 row_mask:0xf bank_mask:0xf
    v_min_f32_dpp v79, v71, v71 row_ror:2 row_mask:0xf bank_mask:0xf
    v_mov_b32 v64, v72
    v_mov_b32 v68, v76
    v_mov_b32 v65, v73
    v_mov_b32 v69, v77
    v_mov_b32 v66, v74
    v_mov_b32 v70, v78
    v_mov_b32 v67, v75
    v_mov_b32 v71, v79
    s_nop 0
    v_max_f32_dpp v72, v64, v64 row_ror:1 row_mask:0xf bank_mask:0xf
    v_min_f32_dpp v76, v68, v68 row_ror:1 row_mask:0xf bank_mask:0xf
    v_max_f32_dpp v73, v65, v65 row_ror:1 row_mask:0xf bank_mask:0xf
    v_min_f32_dpp v77, v69, v69 row_ror:1 row_mask:0xf bank_mask:0xf
    v_max_f32_dpp v74, v66, v66 row_ror:1 row_mask:0xf bank_mask:0xf
    v_min_f32_dpp v78, v70, v70 row_ror:1 row_mask:0xf bank_mask:0xf
    v_max_f32_dpp v75, v67, v67 row_ror:1 row_mask:0xf bank_mask:0xf
    v_min_f32_dpp v79, v71, v71 row_ror:1 row_mask:0xf bank_mask:0xf
    v_mov_b32 v64, v72
    v_mov_b32 v68, v76
    v_mov_b32 v65, v73
    v_mov_b32 v69, v77
    v_mov_b32 v66, v74
    v_mov_b32 v70, v78
    v_mov_b32 v67, v75
    v_mov_b32 v71, v79
    v_sub_f32 v72, v56, v64
    v_sub_f32 v76, v68, v56
    v_sub_f32 v73, v57, v65
    v_sub_f32 v77, v69, v57
    v_sub_f32 v74, v58, v66
    v_sub_f32 v78, v70, v58
    v_sub_f32 v75, v59, v67
    v_sub_f32 v79, v71, v59
    v_mul_f32 v72, 0x3fb8aa3b, v72
    v_mul_f32 v73, 0x3fb8aa3b, v73
    v_mul_f32 v74, 0x3fb8aa3b, v74
    v_mul_f32 v75, 0x3fb8aa3b, v75
    v_mul_f32 v76, 0x3fb8aa3b, v76
    v_mul_f32 v77, 0x3fb8aa3b, v77
    v_mul_f32 v78, 0x3fb8aa3b, v78
    v_mul_f32 v79, 0x3fb8aa3b, v79
    v_exp_f32 v72, v72
    v_exp_f32 v73, v73
    v_exp_f32 v74, v74
    v_exp_f32 v75, v75
    v_exp_f32 v76, v76
    v_exp_f32 v77, v77
    v_exp_f32 v78, v78
    v_exp_f32 v79, v79
    s_nop 0
    v_mov_b32 v64, v72
    v_mov_b32 v65, v73
    v_mov_b32 v66, v74
    v_mov_b32 v67, v75
    v_mov_b32 v68, v76
    v_mov_b32 v69, v77
    v_mov_b32 v70, v78
    v_mov_b32 v71, v79
    s_nop 0
    v_add_f32_dpp v80, v64, v64 row_ror:8 row_mask:0xf bank_mask:0xf
    v_add_f32_dpp v81, v65, v65 row_ror:8 row_mask:0xf bank_mask:0xf
    v_add_f32_dpp v82, v66, v66 row_ror:8 row_mask:0xf bank_mask:0xf
    v_add_f32_dpp v83, v67, v67 row_ror:8 row_mask:0xf bank_mask:0xf
    v_add_f32_dpp v84, v68, v68 row_ror:8 row_mask:0xf bank_mask:0xf
    v_add_f32_dpp v85, v69, v69 row_ror:8 row_mask:0xf bank_mask:0xf
    v_add_f32_dpp v86, v70, v70 row_ror:8 row_mask:0xf bank_mask:0xf
    v_add_f32_dpp v87, v71, v71 row_ror:8 row_mask:0xf bank_mask:0xf
    v_mov_b32 v64, v80
    v_mov_b32 v65, v81
    v_mov_b32 v66, v82
    v_mov_b32 v67, v83
    v_mov_b32 v68, v84
    v_mov_b32 v69, v85
    v_mov_b32 v70, v86
    v_mov_b32 v71, v87
    s_nop 0
    v_add_f32_dpp v80, v64, v64 row_ror:4 row_mask:0xf bank_mask:0xf
    v_add_f32_dpp v81, v65, v65 row_ror:4 row_mask:0xf bank_mask:0xf
    v_add_f32_dpp v82, v66, v66 row_ror:4 row_mask:0xf bank_mask:0xf
    v_add_f32_dpp v83, v67, v67 row_ror:4 row_mask:0xf bank_mask:0xf
    v_add_f32_dpp v84, v68, v68 row_ror:4 row_mask:0xf bank_mask:0xf
    v_add_f32_dpp v85, v69, v69 row_ror:4 row_mask:0xf bank_mask:0xf
    v_add_f32_dpp v86, v70, v70 row_ror:4 row_mask:0xf bank_mask:0xf
    v_add_f32_dpp v87, v71, v71 row_ror:4 row_mask:0xf bank_mask:0xf
    v_mov_b32 v64, v80
    v_mov_b32 v65, v81
    v_mov_b32 v66, v82
    v_mov_b32 v67, v83
    v_mov_b32 v68, v84
    v_mov_b32 v69, v85
    v_mov_b32 v70, v86
    v_mov_b32 v71, v87
    s_nop 0
    v_add_f32_dpp v80, v64, v64 row_ror:2 row_mask:0xf bank_mask:0xf
    v_add_f32_dpp v81, v65, v65 row_ror:2 row_mask:0xf bank_mask:0xf
    v_add_f32_dpp v82, v66, v66 row_ror:2 row_mask:0xf bank_mask:0xf
    v_add_f32_dpp v83, v67, v67 row_ror:2 row_mask:0xf bank_mask:0xf
    v_add_f32_dpp v84, v68, v68 row_ror:2 row_mask:0xf bank_mask:0xf
    v_add_f32_dpp v85, v69, v69 row_ror:2 row_mask:0xf bank_mask:0xf
    v_add_f32_dpp v86, v70, v70 row_ror:2 row_mask:0xf bank_mask:0xf
    v_add_f32_dpp v87, v71, v71 row_ror:2 row_mask:0xf bank_mask:0xf
    v_mov_b32 v64, v80
    v_mov_b32 v65, v81
    v_mov_b32 v66, v82
    v_mov_b32 v67, v83
    v_mov_b32 v68, v84
    v_mov_b32 v69, v85
    v_mov_b32 v70, v86
    v_mov_b32 v71, v87
    s_nop 0
    v_add_f32_dpp v80, v64, v64 row_ror:1 row_mask:0xf bank_mask:0xf
    v_add_f32_dpp v81, v65, v65 row_ror:1 row_mask:0xf bank_mask:0xf
    v_add_f32_dpp v82, v66, v66 row_ror:1 row_mask:0xf bank_mask:0xf
    v_add_f32_dpp v83, v67, v67 row_ror:1 row_mask:0xf bank_mask:0xf
    v_add_f32_dpp v84, v68, v68 row_ror:1 row_mask:0xf bank_mask:0xf
    v_add_f32_dpp v85, v69, v69 row_ror:1 row_mask:0xf bank_mask:0xf
    v_add_f32_dpp v86, v70, v70 row_ror:1 row_mask:0xf bank_mask:0xf
    v_add_f32_dpp v87, v71, v71 row_ror:1 row_mask:0xf bank_mask:0xf
    v_mov_b32 v64, v80
    v_mov_b32 v65, v81
    v_mov_b32 v66, v82
    v_mov_b32 v67, v83
    v_mov_b32 v68, v84
    v_mov_b32 v69, v85
    v_mov_b32 v70, v86
    v_mov_b32 v71, v87
    v_rcp_f32 v64, v64
    v_rcp_f32 v65, v65
    v_rcp_f32 v66, v66
    v_rcp_f32 v67, v67
    v_rcp_f32 v68, v68
    v_rcp_f32 v69, v69
    v_rcp_f32 v70, v70
    v_rcp_f32 v71, v71
    s_nop 0
    v_mul_f32 v72, v72, v64
    v_mul_f32 v73, v73, v65
    v_mul_f32 v74, v74, v66
    v_mul_f32 v75, v75, v67
    v_mul_f32 v76, v76, v68
    v_mul_f32 v77, v77, v69
    v_mul_f32 v78, v78, v70
    v_mul_f32 v79, v79, v71
    v_cvt_pk_bf16_f32 v88, v72, v73
    v_cvt_pk_bf16_f32 v89, v74, v75
    v_cvt_pk_bf16_f32 v92, v76, v77
    v_cvt_pk_bf16_f32 v93, v78, v79
    v_cvt_pk_bf16_f32 v96, v20, v21
    v_cvt_pk_bf16_f32 v97, v22, v23
    v_cvt_pk_bf16_f32 v54, v24, v25
    v_cvt_pk_bf16_f32 v55, v26, v27
    v_mov_b32 v56, 0
    v_mov_b32 v57, 0
    v_mov_b32 v58, 0
    v_mov_b32 v59, 0
    s_nop 1
    v_mfma_f32_16x16x16_bf16 v[56:59], v[54:55], v[52:53], v[56:59]
    s_nop 9
    v_cvt_pk_bf16_f32 v60, v56, v57
    v_cvt_pk_bf16_f32 v61, v58, v59
    v_lshlrev_b32 v56, 16, v60
    v_and_b32 v57, 0xffff0000, v60
    v_lshlrev_b32 v58, 16, v61
    v_and_b32 v59, 0xffff0000, v61
    v_mov_b32 v64, v56
    v_mov_b32 v68, v56
    v_mov_b32 v65, v57
    v_mov_b32 v69, v57
    v_mov_b32 v66, v58
    v_mov_b32 v70, v58
    v_mov_b32 v67, v59
    v_mov_b32 v71, v59
    s_nop 0
    v_max_f32_dpp v72, v64, v64 row_ror:8 row_mask:0xf bank_mask:0xf
    v_min_f32_dpp v76, v68, v68 row_ror:8 row_mask:0xf bank_mask:0xf
    v_max_f32_dpp v73, v65, v65 row_ror:8 row_mask:0xf bank_mask:0xf
    v_min_f32_dpp v77, v69, v69 row_ror:8 row_mask:0xf bank_mask:0xf
    v_max_f32_dpp v74, v66, v66 row_ror:8 row_mask:0xf bank_mask:0xf
    v_min_f32_dpp v78, v70, v70 row_ror:8 row_mask:0xf bank_mask:0xf
    v_max_f32_dpp v75, v67, v67 row_ror:8 row_mask:0xf bank_mask:0xf
    v_min_f32_dpp v79, v71, v71 row_ror:8 row_mask:0xf bank_mask:0xf
    v_mov_b32 v64, v72
    v_mov_b32 v68, v76
    v_mov_b32 v65, v73
    v_mov_b32 v69, v77
    v_mov_b32 v66, v74
    v_mov_b32 v70, v78
    v_mov_b32 v67, v75
    v_mov_b32 v71, v79
    s_nop 0
    v_max_f32_dpp v72, v64, v64 row_ror:4 row_mask:0xf bank_mask:0xf
    v_min_f32_dpp v76, v68, v68 row_ror:4 row_mask:0xf bank_mask:0xf
    v_max_f32_dpp v73, v65, v65 row_ror:4 row_mask:0xf bank_mask:0xf
    v_min_f32_dpp v77, v69, v69 row_ror:4 row_mask:0xf bank_mask:0xf
    v_max_f32_dpp v74, v66, v66 row_ror:4 row_mask:0xf bank_mask:0xf
    v_min_f32_dpp v78, v70, v70 row_ror:4 row_mask:0xf bank_mask:0xf
    v_max_f32_dpp v75, v67, v67 row_ror:4 row_mask:0xf bank_mask:0xf
    v_min_f32_dpp v79, v71, v71 row_ror:4 row_mask:0xf bank_mask:0xf
    v_mov_b32 v64, v72
    v_mov_b32 v68, v76
    v_mov_b32 v65, v73
    v_mov_b32 v69, v77
    v_mov_b32 v66, v74
    v_mov_b32 v70, v78
    v_mov_b32 v67, v75
    v_mov_b32 v71, v79
    s_nop 0
    v_max_f32_dpp v72, v64, v64 row_ror:2 row_mask:0xf bank_mask:0xf
    v_min_f32_dpp v76, v68, v68 row_ror:2 row_mask:0xf bank_mask:0xf
    v_max_f32_dpp v73, v65, v65 row_ror:2 row_mask:0xf bank_mask:0xf
    v_min_f32_dpp v77, v69, v69 row_ror:2 row_mask:0xf bank_mask:0xf
    v_max_f32_dpp v74, v66, v66 row_ror:2 row_mask:0xf bank_mask:0xf
    v_min_f32_dpp v78, v70, v70 row_ror:2 row_mask:0xf bank_mask:0xf
    v_max_f32_dpp v75, v67, v67 row_ror:2 row_mask:0xf bank_mask:0xf
    v_min_f32_dpp v79, v71, v71 row_ror:2 row_mask:0xf bank_mask:0xf
    v_mov_b32 v64, v72
    v_mov_b32 v68, v76
    v_mov_b32 v65, v73
    v_mov_b32 v69, v77
    v_mov_b32 v66, v74
    v_mov_b32 v70, v78
    v_mov_b32 v67, v75
    v_mov_b32 v71, v79
    s_nop 0
    v_max_f32_dpp v72, v64, v64 row_ror:1 row_mask:0xf bank_mask:0xf
    v_min_f32_dpp v76, v68, v68 row_ror:1 row_mask:0xf bank_mask:0xf
    v_max_f32_dpp v73, v65, v65 row_ror:1 row_mask:0xf bank_mask:0xf
    v_min_f32_dpp v77, v69, v69 row_ror:1 row_mask:0xf bank_mask:0xf
    v_max_f32_dpp v74, v66, v66 row_ror:1 row_mask:0xf bank_mask:0xf
    v_min_f32_dpp v78, v70, v70 row_ror:1 row_mask:0xf bank_mask:0xf
    v_max_f32_dpp v75, v67, v67 row_ror:1 row_mask:0xf bank_mask:0xf
    v_min_f32_dpp v79, v71, v71 row_ror:1 row_mask:0xf bank_mask:0xf
    v_mov_b32 v64, v72
    v_mov_b32 v68, v76
    v_mov_b32 v65, v73
    v_mov_b32 v69, v77
    v_mov_b32 v66, v74
    v_mov_b32 v70, v78
    v_mov_b32 v67, v75
    v_mov_b32 v71, v79
    v_sub_f32 v72, v56, v64
    v_sub_f32 v76, v68, v56
    v_sub_f32 v73, v57, v65
    v_sub_f32 v77, v69, v57
    v_sub_f32 v74, v58, v66
    v_sub_f32 v78, v70, v58
    v_sub_f32 v75, v59, v67
    v_sub_f32 v79, v71, v59
    v_mul_f32 v72, 0x3fb8aa3b, v72
    v_mul_f32 v73, 0x3fb8aa3b, v73
    v_mul_f32 v74, 0x3fb8aa3b, v74
    v_mul_f32 v75, 0x3fb8aa3b, v75
    v_mul_f32 v76, 0x3fb8aa3b, v76
    v_mul_f32 v77, 0x3fb8aa3b, v77
    v_mul_f32 v78, 0x3fb8aa3b, v78
    v_mul_f32 v79, 0x3fb8aa3b, v79
    v_exp_f32 v72, v72
    v_exp_f32 v73, v73
    v_exp_f32 v74, v74
    v_exp_f32 v75, v75
    v_exp_f32 v76, v76
    v_exp_f32 v77, v77
    v_exp_f32 v78, v78
    v_exp_f32 v79, v79
    s_nop 0
    v_mov_b32 v64, v72
    v_mov_b32 v65, v73
    v_mov_b32 v66, v74
    v_mov_b32 v67, v75
    v_mov_b32 v68, v76
    v_mov_b32 v69, v77
    v_mov_b32 v70, v78
    v_mov_b32 v71, v79
    s_nop 0
    v_add_f32_dpp v80, v64, v64 row_ror:8 row_mask:0xf bank_mask:0xf
    v_add_f32_dpp v81, v65, v65 row_ror:8 row_mask:0xf bank_mask:0xf
    v_add_f32_dpp v82, v66, v66 row_ror:8 row_mask:0xf bank_mask:0xf
    v_add_f32_dpp v83, v67, v67 row_ror:8 row_mask:0xf bank_mask:0xf
    v_add_f32_dpp v84, v68, v68 row_ror:8 row_mask:0xf bank_mask:0xf
    v_add_f32_dpp v85, v69, v69 row_ror:8 row_mask:0xf bank_mask:0xf
    v_add_f32_dpp v86, v70, v70 row_ror:8 row_mask:0xf bank_mask:0xf
    v_add_f32_dpp v87, v71, v71 row_ror:8 row_mask:0xf bank_mask:0xf
    v_mov_b32 v64, v80
    v_mov_b32 v65, v81
    v_mov_b32 v66, v82
    v_mov_b32 v67, v83
    v_mov_b32 v68, v84
    v_mov_b32 v69, v85
    v_mov_b32 v70, v86
    v_mov_b32 v71, v87
    s_nop 0
    v_add_f32_dpp v80, v64, v64 row_ror:4 row_mask:0xf bank_mask:0xf
    v_add_f32_dpp v81, v65, v65 row_ror:4 row_mask:0xf bank_mask:0xf
    v_add_f32_dpp v82, v66, v66 row_ror:4 row_mask:0xf bank_mask:0xf
    v_add_f32_dpp v83, v67, v67 row_ror:4 row_mask:0xf bank_mask:0xf
    v_add_f32_dpp v84, v68, v68 row_ror:4 row_mask:0xf bank_mask:0xf
    v_add_f32_dpp v85, v69, v69 row_ror:4 row_mask:0xf bank_mask:0xf
    v_add_f32_dpp v86, v70, v70 row_ror:4 row_mask:0xf bank_mask:0xf
    v_add_f32_dpp v87, v71, v71 row_ror:4 row_mask:0xf bank_mask:0xf
    v_mov_b32 v64, v80
    v_mov_b32 v65, v81
    v_mov_b32 v66, v82
    v_mov_b32 v67, v83
    v_mov_b32 v68, v84
    v_mov_b32 v69, v85
    v_mov_b32 v70, v86
    v_mov_b32 v71, v87
    s_nop 0
    v_add_f32_dpp v80, v64, v64 row_ror:2 row_mask:0xf bank_mask:0xf
    v_add_f32_dpp v81, v65, v65 row_ror:2 row_mask:0xf bank_mask:0xf
    v_add_f32_dpp v82, v66, v66 row_ror:2 row_mask:0xf bank_mask:0xf
    v_add_f32_dpp v83, v67, v67 row_ror:2 row_mask:0xf bank_mask:0xf
    v_add_f32_dpp v84, v68, v68 row_ror:2 row_mask:0xf bank_mask:0xf
    v_add_f32_dpp v85, v69, v69 row_ror:2 row_mask:0xf bank_mask:0xf
    v_add_f32_dpp v86, v70, v70 row_ror:2 row_mask:0xf bank_mask:0xf
    v_add_f32_dpp v87, v71, v71 row_ror:2 row_mask:0xf bank_mask:0xf
    v_mov_b32 v64, v80
    v_mov_b32 v65, v81
    v_mov_b32 v66, v82
    v_mov_b32 v67, v83
    v_mov_b32 v68, v84
    v_mov_b32 v69, v85
    v_mov_b32 v70, v86
    v_mov_b32 v71, v87
    s_nop 0
    v_add_f32_dpp v80, v64, v64 row_ror:1 row_mask:0xf bank_mask:0xf
    v_add_f32_dpp v81, v65, v65 row_ror:1 row_mask:0xf bank_mask:0xf
    v_add_f32_dpp v82, v66, v66 row_ror:1 row_mask:0xf bank_mask:0xf
    v_add_f32_dpp v83, v67, v67 row_ror:1 row_mask:0xf bank_mask:0xf
    v_add_f32_dpp v84, v68, v68 row_ror:1 row_mask:0xf bank_mask:0xf
    v_add_f32_dpp v85, v69, v69 row_ror:1 row_mask:0xf bank_mask:0xf
    v_add_f32_dpp v86, v70, v70 row_ror:1 row_mask:0xf bank_mask:0xf
    v_add_f32_dpp v87, v71, v71 row_ror:1 row_mask:0xf bank_mask:0xf
    v_mov_b32 v64, v80
    v_mov_b32 v65, v81
    v_mov_b32 v66, v82
    v_mov_b32 v67, v83
    v_mov_b32 v68, v84
    v_mov_b32 v69, v85
    v_mov_b32 v70, v86
    v_mov_b32 v71, v87
    v_rcp_f32 v64, v64
    v_rcp_f32 v65, v65
    v_rcp_f32 v66, v66
    v_rcp_f32 v67, v67
    v_rcp_f32 v68, v68
    v_rcp_f32 v69, v69
    v_rcp_f32 v70, v70
    v_rcp_f32 v71, v71
    s_nop 0
    v_mul_f32 v72, v72, v64
    v_mul_f32 v73, v73, v65
    v_mul_f32 v74, v74, v66
    v_mul_f32 v75, v75, v67
    v_mul_f32 v76, v76, v68
    v_mul_f32 v77, v77, v69
    v_mul_f32 v78, v78, v70
    v_mul_f32 v79, v79, v71
    v_cvt_pk_bf16_f32 v90, v72, v73
    v_cvt_pk_bf16_f32 v91, v74, v75
    v_cvt_pk_bf16_f32 v94, v76, v77
    v_cvt_pk_bf16_f32 v95, v78, v79
    v_cvt_pk_bf16_f32 v98, v28, v29
    v_cvt_pk_bf16_f32 v99, v30, v31
    v_mov_b32 v100, 0x3f803f80
    v_mov_b32 v101, 0x3f803f80
    v_mov_b32 v102, 0x3f803f80
    v_mov_b32 v103, 0x3f803f80
    v_mov_b32 v104, 0
    v_mov_b32 v105, 0
    v_mov_b32 v106, 0
    v_mov_b32 v107, 0
    v_mov_b32 v108, 0
    v_mov_b32 v109, 0
    v_mov_b32 v110, 0
    v_mov_b32 v111, 0
    v_mov_b32 v112, 0
    v_mov_b32 v113, 0
    v_mov_b32 v114, 0
    v_mov_b32 v115, 0
    v_mov_b32 v116, 0
    v_mov_b32 v117, 0
    v_mov_b32 v118, 0
    v_mov_b32 v119, 0
    s_nop 1
    v_mfma_f32_16x16x32_bf16 v[104:107], v[88:91], v[96:99], v[104:107]
    v_mfma_f32_16x16x32_bf16 v[108:111], v[92:95], v[96:99], v[108:111]
    v_mfma_f32_16x16x32_bf16 v[112:115], v[88:91], v[100:103], v[112:115]
    v_mfma_f32_16x16x32_bf16 v[116:119], v[92:95], v[100:103], v[116:119]
    s_nop 11
    s_lshl_b32 s31, s21, 11
    s_add_u32 s31, s31, 13631488
    s_add_u32 s32, s12, s31
    s_addc_u32 s33, s13, 0
    v_lshlrev_b32 v48, 2, v1
    global_atomic_add_f32 v48, v104, s[32:33] offset:0
    global_atomic_add_f32 v48, v105, s[32:33] offset:256
    global_atomic_add_f32 v48, v106, s[32:33] offset:512
    global_atomic_add_f32 v48, v107, s[32:33] offset:768
    global_atomic_add_f32 v48, v108, s[32:33] offset:1024
    global_atomic_add_f32 v48, v109, s[32:33] offset:1280
    global_atomic_add_f32 v48, v110, s[32:33] offset:1536
    global_atomic_add_f32 v48, v111, s[32:33] offset:1792
    s_add_u32 s32, s32, 65536
    s_addc_u32 s33, s33, 0
    global_atomic_add_f32 v48, v112, s[32:33] offset:0
    global_atomic_add_f32 v48, v113, s[32:33] offset:256
    global_atomic_add_f32 v48, v114, s[32:33] offset:512
    global_atomic_add_f32 v48, v115, s[32:33] offset:768
    global_atomic_add_f32 v48, v116, s[32:33] offset:1024
    global_atomic_add_f32 v48, v117, s[32:33] offset:1280
    global_atomic_add_f32 v48, v118, s[32:33] offset:1536
    global_atomic_add_f32 v48, v119, s[32:33] offset:1792
    s_branch L1_next
L1_main_std:
    s_and_b32 s21, s19, 7
    s_lshl_b32 s21, s21, 2
    s_add_u32 s21, s21, s18
    s_lshl_b32 s31, s21, 9
    s_add_u32 s32, s6, s31
    s_addc_u32 s33, s7, 0
    global_load_ushort v120, v15, s[32:33] offset:0
    global_load_ushort v121, v15, s[32:33] offset:32
    global_load_ushort v122, v15, s[32:33] offset:64
    global_load_ushort v123, v15, s[32:33] offset:96
    s_add_u32 s21, s21, 2
    s_lshl_b32 s31, s21, 9
    s_add_u32 s32, s6, s31
    s_addc_u32 s33, s7, 0
    global_load_ushort v124, v15, s[32:33] offset:0
    global_load_ushort v125, v15, s[32:33] offset:32
    global_load_ushort v126, v15, s[32:33] offset:64
    global_load_ushort v127, v15, s[32:33] offset:96
    v_mov_b32 v16, 0
    v_mov_b32 v17, 0
    v_mov_b32 v18, 0
    v_mov_b32 v19, 0
    v_mov_b32 v20, 0
    v_mov_b32 v21, 0
    v_mov_b32 v22, 0
    v_mov_b32 v23, 0
    v_mov_b32 v24, 0
    v_mov_b32 v25, 0
    v_mov_b32 v26, 0
    v_mov_b32 v27, 0
    v_mov_b32 v28, 0
    v_mov_b32 v29, 0
    v_mov_b32 v30, 0
    v_mov_b32 v31, 0
    ds_read_b64_tr_b16 v[32:33], v4 offset:0
    ds_read_b64_tr_b16 v[34:35], v4 offset:2048
    ds_read_b64_tr_b16 v[36:37], v5 offset:0
    ds_read_b64_tr_b16 v[38:39], v5 offset:2048
    ds_read_b64_tr_b16 v[40:41], v4 offset:4096
    ds_read_b64_tr_b16 v[42:43], v4 offset:6144
    ds_read_b64_tr_b16 v[44:45], v5 offset:4096
    ds_read_b64_tr_b16 v[46:47], v5 offset:6144
    s_waitcnt lgkmcnt(4)
    v_mfma_f32_16x16x32_bf16 v[16:19], v[32:35], v[128:131], v[16:19]
    v_mfma_f32_16x16x32_bf16 v[20:23], v[36:39], v[128:131], v[20:23]
    v_mfma_f32_16x16x32_bf16 v[24:27], v[32:35], v[192:195], v[24:27]
    v_mfma_f32_16x16x32_bf16 v[28:31], v[36:39], v[192:195], v[28:31]
    ds_read_b64_tr_b16 v[32:33], v4 offset:8192
    ds_read_b64_tr_b16 v[34:35], v4 offset:10240
    ds_read_b64_tr_b16 v[36:37], v5 offset:8192
    ds_read_b64_tr_b16 v[38:39], v5 offset:10240
    s_waitcnt lgkmcnt(4)
    v_mfma_f32_16x16x32_bf16 v[16:19], v[40:43], v[132:135], v[16:19]
    v_mfma_f32_16x16x32_bf16 v[20:23], v[44:47], v[132:135], v[20:23]
    v_mfma_f32_16x16x32_bf16 v[24:27], v[40:43], v[196:199], v[24:27]
    v_mfma_f32_16x16x32_bf16 v[28:31], v[44:47], v[196:199], v[28:31]
    ds_read_b64_tr_b16 v[40:41], v4 offset:12288
    ds_read_b64_tr_b16 v[42:43], v4 offset:14336
    ds_read_b64_tr_b16 v[44:45], v5 offset:12288
    ds_read_b64_tr_b16 v[46:47], v5 offset:14336
    s_waitcnt lgkmcnt(4)
    v_mfma_f32_16x16x32_bf16 v[16:19], v[32:35], v[136:139], v[16:19]
    v_mfma_f32_16x16x32_bf16 v[20:23], v[36:39], v[136:139], v[20:23]
    v_mfma_f32_16x16x32_bf16 v[24:27], v[32:35], v[200:203], v[24:27]
    v_mfma_f32_16x16x32_bf16 v[28:31], v[36:39], v[200:203], v[28:31]
    ds_read_b64_tr_b16 v[32:33], v4 offset:16384
    ds_read_b64_tr_b16 v[34:35], v4 offset:18432
    ds_read_b64_tr_b16 v[36:37], v5 offset:16384
    ds_read_b64_tr_b16 v[38:39], v5 offset:18432
    s_waitcnt lgkmcnt(4)
    v_mfma_f32_16x16x32_bf16 v[16:19], v[40:43], v[140:143], v[16:19]
    v_mfma_f32_16x16x32_bf16 v[20:23], v[44:47], v[140:143], v[20:23]
    v_mfma_f32_16x16x32_bf16 v[24:27], v[40:43], v[204:207], v[24:27]
    v_mfma_f32_16x16x32_bf16 v[28:31], v[44:47], v[204:207], v[28:31]
    ds_read_b64_tr_b16 v[40:41], v4 offset:20480
    ds_read_b64_tr_b16 v[42:43], v4 offset:22528
    ds_read_b64_tr_b16 v[44:45], v5 offset:20480
    ds_read_b64_tr_b16 v[46:47], v5 offset:22528
    s_waitcnt lgkmcnt(4)
    v_mfma_f32_16x16x32_bf16 v[16:19], v[32:35], v[144:147], v[16:19]
    v_mfma_f32_16x16x32_bf16 v[20:23], v[36:39], v[144:147], v[20:23]
    v_mfma_f32_16x16x32_bf16 v[24:27], v[32:35], v[208:211], v[24:27]
    v_mfma_f32_16x16x32_bf16 v[28:31], v[36:39], v[208:211], v[28:31]
    ds_read_b64_tr_b16 v[32:33], v4 offset:24576
    ds_read_b64_tr_b16 v[34:35], v4 offset:26624
    ds_read_b64_tr_b16 v[36:37], v5 offset:24576
    ds_read_b64_tr_b16 v[38:39], v5 offset:26624
    s_waitcnt lgkmcnt(4)
    v_mfma_f32_16x16x32_bf16 v[16:19], v[40:43], v[148:151], v[16:19]
    v_mfma_f32_16x16x32_bf16 v[20:23], v[44:47], v[148:151], v[20:23]
    v_mfma_f32_16x16x32_bf16 v[24:27], v[40:43], v[212:215], v[24:27]
    v_mfma_f32_16x16x32_bf16 v[28:31], v[44:47], v[212:215], v[28:31]
    ds_read_b64_tr_b16 v[40:41], v4 offset:28672
    ds_read_b64_tr_b16 v[42:43], v4 offset:30720
    ds_read_b64_tr_b16 v[44:45], v5 offset:28672
    ds_read_b64_tr_b16 v[46:47], v5 offset:30720
    s_waitcnt lgkmcnt(4)
    v_mfma_f32_16x16x32_bf16 v[16:19], v[32:35], v[152:155], v[16:19]
    v_mfma_f32_16x16x32_bf16 v[20:23], v[36:39], v[152:155], v[20:23]
    v_mfma_f32_16x16x32_bf16 v[24:27], v[32:35], v[216:219], v[24:27]
    v_mfma_f32_16x16x32_bf16 v[28:31], v[36:39], v[216:219], v[28:31]
    ds_read_b64_tr_b16 v[32:33], v4 offset:32768
    ds_read_b64_tr_b16 v[34:35], v4 offset:34816
    ds_read_b64_tr_b16 v[36:37], v5 offset:32768
    ds_read_b64_tr_b16 v[38:39], v5 offset:34816
    s_waitcnt lgkmcnt(4)
    v_mfma_f32_16x16x32_bf16 v[16:19], v[40:43], v[156:159], v[16:19]
    v_mfma_f32_16x16x32_bf16 v[20:23], v[44:47], v[156:159], v[20:23]
    v_mfma_f32_16x16x32_bf16 v[24:27], v[40:43], v[220:223], v[24:27]
    v_mfma_f32_16x16x32_bf16 v[28:31], v[44:47], v[220:223], v[28:31]
    ds_read_b64_tr_b16 v[40:41], v4 offset:36864
    ds_read_b64_tr_b16 v[42:43], v4 offset:38912
    ds_read_b64_tr_b16 v[44:45], v5 offset:36864
    ds_read_b64_tr_b16 v[46:47], v5 offset:38912
    s_waitcnt lgkmcnt(4)
    v_mfma_f32_16x16x32_bf16 v[16:19], v[32:35], v[160:163], v[16:19]
    v_mfma_f32_16x16x32_bf16 v[20:23], v[36:39], v[160:163], v[20:23]
    v_mfma_f32_16x16x32_bf16 v[24:27], v[32:35], v[224:227], v[24:27]
    v_mfma_f32_16x16x32_bf16 v[28:31], v[36:39], v[224:227], v[28:31]
    ds_read_b64_tr_b16 v[32:33], v4 offset:40960
    ds_read_b64_tr_b16 v[34:35], v4 offset:43008
    ds_read_b64_tr_b16 v[36:37], v5 offset:40960
    ds_read_b64_tr_b16 v[38:39], v5 offset:43008
    s_waitcnt lgkmcnt(4)
    v_mfma_f32_16x16x32_bf16 v[16:19], v[40:43], v[164:167], v[16:19]
    v_mfma_f32_16x16x32_bf16 v[20:23], v[44:47], v[164:167], v[20:23]
    v_mfma_f32_16x16x32_bf16 v[24:27], v[40:43], v[228:231], v[24:27]
    v_mfma_f32_16x16x32_bf16 v[28:31], v[44:47], v[228:231], v[28:31]
    ds_read_b64_tr_b16 v[40:41], v4 offset:45056
    ds_read_b64_tr_b16 v[42:43], v4 offset:47104
    ds_read_b64_tr_b16 v[44:45], v5 offset:45056
    ds_read_b64_tr_b16 v[46:47], v5 offset:47104
    s_waitcnt lgkmcnt(4)
    v_mfma_f32_16x16x32_bf16 v[16:19], v[32:35], v[168:171], v[16:19]
    v_mfma_f32_16x16x32_bf16 v[20:23], v[36:39], v[168:171], v[20:23]
    v_mfma_f32_16x16x32_bf16 v[24:27], v[32:35], v[232:235], v[24:27]
    v_mfma_f32_16x16x32_bf16 v[28:31], v[36:39], v[232:235], v[28:31]
    ds_read_b64_tr_b16 v[32:33], v4 offset:49152
    ds_read_b64_tr_b16 v[34:35], v4 offset:51200
    ds_read_b64_tr_b16 v[36:37], v5 offset:49152
    ds_read_b64_tr_b16 v[38:39], v5 offset:51200
    s_waitcnt lgkmcnt(4)
    v_mfma_f32_16x16x32_bf16 v[16:19], v[40:43], v[172:175], v[16:19]
    v_mfma_f32_16x16x32_bf16 v[20:23], v[44:47], v[172:175], v[20:23]
    v_mfma_f32_16x16x32_bf16 v[24:27], v[40:43], v[236:239], v[24:27]
    v_mfma_f32_16x16x32_bf16 v[28:31], v[44:47], v[236:239], v[28:31]
    ds_read_b64_tr_b16 v[40:41], v4 offset:53248
    ds_read_b64_tr_b16 v[42:43], v4 offset:55296
    ds_read_b64_tr_b16 v[44:45], v5 offset:53248
    ds_read_b64_tr_b16 v[46:47], v5 offset:55296
    s_waitcnt lgkmcnt(4)
    v_mfma_f32_16x16x32_bf16 v[16:19], v[32:35], v[176:179], v[16:19]
    v_mfma_f32_16x16x32_bf16 v[20:23], v[36:39], v[176:179], v[20:23]
    v_mfma_f32_16x16x32_bf16 v[24:27], v[32:35], v[240:243], v[24:27]
    v_mfma_f32_16x16x32_bf16 v[28:31], v[36:39], v[240:243], v[28:31]
    ds_read_b64_tr_b16 v[32:33], v4 offset:57344
    ds_read_b64_tr_b16 v[34:35], v4 offset:59392
    ds_read_b64_tr_b16 v[36:37], v5 offset:57344
    ds_read_b64_tr_b16 v[38:39], v5 offset:59392
    s_waitcnt lgkmcnt(4)
    v_mfma_f32_16x16x32_bf16 v[16:19], v[40:43], v[180:183], v[16:19]
    v_mfma_f32_16x16x32_bf16 v[20:23], v[44:47], v[180:183], v[20:23]
    v_mfma_f32_16x16x32_bf16 v[24:27], v[40:43], v[244:247], v[24:27]
    v_mfma_f32_16x16x32_bf16 v[28:31], v[44:47], v[244:247], v[28:31]
    ds_read_b64_tr_b16 v[40:41], v4 offset:61440
    ds_read_b64_tr_b16 v[42:43], v4 offset:63488
    ds_read_b64_tr_b16 v[44:45], v5 offset:61440
    ds_read_b64_tr_b16 v[46:47], v5 offset:63488
    s_waitcnt lgkmcnt(4)
    v_mfma_f32_16x16x32_bf16 v[16:19], v[32:35], v[184:187], v[16:19]
    v_mfma_f32_16x16x32_bf16 v[20:23], v[36:39], v[184:187], v[20:23]
    v_mfma_f32_16x16x32_bf16 v[24:27], v[32:35], v[248:251], v[24:27]
    v_mfma_f32_16x16x32_bf16 v[28:31], v[36:39], v[248:251], v[28:31]
    s_waitcnt lgkmcnt(0)
    v_mfma_f32_16x16x32_bf16 v[16:19], v[40:43], v[188:191], v[16:19]
    v_mfma_f32_16x16x32_bf16 v[20:23], v[44:47], v[188:191], v[20:23]
    v_mfma_f32_16x16x32_bf16 v[24:27], v[40:43], v[252:255], v[24:27]
    v_mfma_f32_16x16x32_bf16 v[28:31], v[44:47], v[252:255], v[28:31]
    s_waitcnt vmcnt(0)
    s_cmp_ge_u32 s20, 4
    s_cbranch_scc1 L1_nofl_0
    ds_write_b128 v11, v[48:51] offset:0
    ds_write_b128 v11, v[52:55] offset:1024
    ds_write_b128 v11, v[56:59] offset:2048
    ds_write_b128 v11, v[60:63] offset:3072
    ds_write_b128 v11, v[64:67] offset:4096
    ds_write_b128 v11, v[68:71] offset:5120
    ds_write_b128 v11, v[72:75] offset:6144
    ds_write_b128 v11, v[76:79] offset:7168
    s_waitcnt lgkmcnt(0)
L1_nofl_0:
    s_nop 9
    s_cmp_ge_u32 s19, 8
    s_cbranch_scc1 L1_ep_mlp
    s_lshl_b32 s21, s19, 2
    s_add_u32 s21, s21, 0
    s_add_u32 s21, s21, s18
    v_lshl_or_b32 v52, v121, 16, v120
    v_lshl_or_b32 v53, v123, 16, v122
    s_lshl_b32 s31, s21, 7
    s_lshl_b32 s34, s14, 3
    s_add_u32 s31, s31, s34
    s_lshl_b32 s34, s17, 1
    s_add_u32 s31, s31, s34
    s_lshl_b32 s31, s31, 10
    s_add_u32 s31, s31, 9437184
    s_add_u32 s32, s12, s31
    s_addc_u32 s33, s13, 0
    v_cvt_pk_bf16_f32 v54, v16, v17
    v_cvt_pk_bf16_f32 v55, v18, v19
    v_mov_b32 v56, 0
    v_mov_b32 v57, 0
    v_mov_b32 v58, 0
    v_mov_b32 v59, 0
    s_nop 1
    v_mfma_f32_16x16x16_bf16 v[56:59], v[52:53], v[54:55], v[56:59]
    s_nop 9
    v_cvt_pk_bf16_f32 v60, v56, v57
    v_cvt_pk_bf16_f32 v61, v58, v59
    v_lshlrev_b32 v56, 16, v60
    v_and_b32 v57, 0xffff0000, v60
    v_lshlrev_b32 v58, 16, v61
    v_and_b32 v59, 0xffff0000, v61
    v_max_f32 v64, v56, v57
    v_max3_f32 v64, v64, v58, v59
    v_min_f32 v65, v56, v57
    v_min3_f32 v65, v65, v58, v59
    v_mov_b32 v66, v64
    s_nop 1
    v_permlane16_swap_b32 v64, v66
    s_nop 0
    v_max_f32 v64, v64, v66
    v_mov_b32 v66, v64
    s_nop 1
    v_permlane32_swap_b32 v64, v66
    s_nop 0
    v_max_f32 v64, v64, v66
    v_mov_b32 v66, v65
    s_nop 1
    v_permlane16_swap_b32 v65, v66
    s_nop 0
    v_min_f32 v65, v65, v66
    v_mov_b32 v66, v65
    s_nop 1
    v_permlane32_swap_b32 v65, v66
    s_nop 0
    v_min_f32 v65, v65, v66
    v_sub_f32 v72, v56, v64
    v_sub_f32 v76, v65, v56
    v_sub_f32 v73, v57, v64
    v_sub_f32 v77, v65, v57
    v_sub_f32 v74, v58, v64
    v_sub_f32 v78, v65, v58
    v_sub_f32 v75, v59, v64
    v_sub_f32 v79, v65, v59
    v_mul_f32 v72, 0x3fb8aa3b, v72
    v_mul_f32 v73, 0x3fb8aa3b, v73
    v_mul_f32 v74, 0x3fb8aa3b, v74
    v_mul_f32 v75, 0x3fb8aa3b, v75
    v_mul_f32 v76, 0x3fb8aa3b, v76
    v_mul_f32 v77, 0x3fb8aa3b, v77
    v_mul_f32 v78, 0x3fb8aa3b, v78
    v_mul_f32 v79, 0x3fb8aa3b, v79
    v_exp_f32 v72, v72
    v_exp_f32 v73, v73
    v_exp_f32 v74, v74
    v_exp_f32 v75, v75
    v_exp_f32 v76, v76
    v_exp_f32 v77, v77
    v_exp_f32 v78, v78
    v_exp_f32 v79, v79
    s_nop 0
    v_add_f32 v64, v72, v73
    v_add_f32 v64, v64, v74
    v_add_f32 v64, v64, v75
    v_add_f32 v65, v76, v77
    v_add_f32 v65, v65, v78
    v_add_f32 v65, v65, v79
    v_mov_b32 v66, v64
    s_nop 1
    v_permlane16_swap_b32 v64, v66
    s_nop 0
    v_add_f32 v64, v64, v66
    v_mov_b32 v66, v64
    s_nop 1
    v_permlane32_swap_b32 v64, v66
    s_nop 0
    v_add_f32 v64, v64, v66
    v_mov_b32 v66, v65
    s_nop 1
    v_permlane16_swap_b32 v65, v66
    s_nop 0
    v_add_f32 v65, v65, v66
    v_mov_b32 v66, v65
    s_nop 1
    v_permlane32_swap_b32 v65, v66
    s_nop 0
    v_add_f32 v65, v65, v66
    v_rcp_f32 v64, v64
    v_rcp_f32 v65, v65
    s_nop 0
    v_mul_f32 v72, v72, v64
    v_mul_f32 v76, v76, v65
    v_mul_f32 v73, v73, v64
    v_mul_f32 v77, v77, v65
    v_mul_f32 v74, v74, v64
    v_mul_f32 v78, v78, v65
    v_mul_f32 v75, v75, v64
    v_mul_f32 v79, v79, v65
    v_cvt_pk_bf16_f32 v84, v72, v73
    v_cvt_pk_bf16_f32 v85, v74, v75
    v_cvt_pk_bf16_f32 v86, v76, v77
    v_cvt_pk_bf16_f32 v87, v78, v79
    v_lshlrev_b32 v48, 4, v1
    global_store_dwordx4 v48, v[84:87], s[32:33] offset:0
    s_nop 1
    v_cvt_pk_bf16_f32 v54, v24, v25
    v_cvt_pk_bf16_f32 v55, v26, v27
    v_mov_b32 v56, 0
    v_mov_b32 v57, 0
    v_mov_b32 v58, 0
    v_mov_b32 v59, 0
    s_nop 1
    v_mfma_f32_16x16x16_bf16 v[56:59], v[52:53], v[54:55], v[56:59]
    s_nop 9
    v_cvt_pk_bf16_f32 v60, v56, v57
    v_cvt_pk_bf16_f32 v61, v58, v59
    v_lshlrev_b32 v56, 16, v60
    v_and_b32 v57, 0xffff0000, v60
    v_lshlrev_b32 v58, 16, v61
    v_and_b32 v59, 0xffff0000, v61
    v_max_f32 v64, v56, v57
    v_max3_f32 v64, v64, v58, v59
    v_min_f32 v65, v56, v57
    v_min3_f32 v65, v65, v58, v59
    v_mov_b32 v66, v64
    s_nop 1
    v_permlane16_swap_b32 v64, v66
    s_nop 0
    v_max_f32 v64, v64, v66
    v_mov_b32 v66, v64
    s_nop 1
    v_permlane32_swap_b32 v64, v66
    s_nop 0
    v_max_f32 v64, v64, v66
    v_mov_b32 v66, v65
    s_nop 1
    v_permlane16_swap_b32 v65, v66
    s_nop 0
    v_min_f32 v65, v65, v66
    v_mov_b32 v66, v65
    s_nop 1
    v_permlane32_swap_b32 v65, v66
    s_nop 0
    v_min_f32 v65, v65, v66
    v_sub_f32 v72, v56, v64
    v_sub_f32 v76, v65, v56
    v_sub_f32 v73, v57, v64
    v_sub_f32 v77, v65, v57
    v_sub_f32 v74, v58, v64
    v_sub_f32 v78, v65, v58
    v_sub_f32 v75, v59, v64
    v_sub_f32 v79, v65, v59
    v_mul_f32 v72, 0x3fb8aa3b, v72
    v_mul_f32 v73, 0x3fb8aa3b, v73
    v_mul_f32 v74, 0x3fb8aa3b, v74
    v_mul_f32 v75, 0x3fb8aa3b, v75
    v_mul_f32 v76, 0x3fb8aa3b, v76
    v_mul_f32 v77, 0x3fb8aa3b, v77
    v_mul_f32 v78, 0x3fb8aa3b, v78
    v_mul_f32 v79, 0x3fb8aa3b, v79
    v_exp_f32 v72, v72
    v_exp_f32 v73, v73
    v_exp_f32 v74, v74
    v_exp_f32 v75, v75
    v_exp_f32 v76, v76
    v_exp_f32 v77, v77
    v_exp_f32 v78, v78
    v_exp_f32 v79, v79
    s_nop 0
    v_add_f32 v64, v72, v73
    v_add_f32 v64, v64, v74
    v_add_f32 v64, v64, v75
    v_add_f32 v65, v76, v77
    v_add_f32 v65, v65, v78
    v_add_f32 v65, v65, v79
    v_mov_b32 v66, v64
    s_nop 1
    v_permlane16_swap_b32 v64, v66
    s_nop 0
    v_add_f32 v64, v64, v66
    v_mov_b32 v66, v64
    s_nop 1
    v_permlane32_swap_b32 v64, v66
    s_nop 0
    v_add_f32 v64, v64, v66
    v_mov_b32 v66, v65
    s_nop 1
    v_permlane16_swap_b32 v65, v66
    s_nop 0
    v_add_f32 v65, v65, v66
    v_mov_b32 v66, v65
    s_nop 1
    v_permlane32_swap_b32 v65, v66
    s_nop 0
    v_add_f32 v65, v65, v66
    v_rcp_f32 v64, v64
    v_rcp_f32 v65, v65
    s_nop 0
    v_mul_f32 v72, v72, v64
    v_mul_f32 v76, v76, v65
    v_mul_f32 v73, v73, v64
    v_mul_f32 v77, v77, v65
    v_mul_f32 v74, v74, v64
    v_mul_f32 v78, v78, v65
    v_mul_f32 v75, v75, v64
    v_mul_f32 v79, v79, v65
    v_cvt_pk_bf16_f32 v84, v72, v73
    v_cvt_pk_bf16_f32 v85, v74, v75
    v_cvt_pk_bf16_f32 v86, v76, v77
    v_cvt_pk_bf16_f32 v87, v78, v79
    v_lshlrev_b32 v48, 4, v1
    global_store_dwordx4 v48, v[84:87], s[32:33] offset:1024
    s_nop 1
    s_lshl_b32 s21, s19, 2
    s_add_u32 s21, s21, 2
    s_add_u32 s21, s21, s18
    v_lshl_or_b32 v52, v125, 16, v124
    v_lshl_or_b32 v53, v127, 16, v126
    s_lshl_b32 s31, s21, 7
    s_lshl_b32 s34, s14, 3
    s_add_u32 s31, s31, s34
    s_lshl_b32 s34, s17, 1
    s_add_u32 s31, s31, s34
    s_lshl_b32 s31, s31, 10
    s_add_u32 s31, s31, 9437184
    s_add_u32 s32, s12, s31
    s_addc_u32 s33, s13, 0
    v_cvt_pk_bf16_f32 v54, v20, v21
    v_cvt_pk_bf16_f32 v55, v22, v23
    v_mov_b32 v56, 0
    v_mov_b32 v57, 0
    v_mov_b32 v58, 0
    v_mov_b32 v59, 0
    s_nop 1
    v_mfma_f32_16x16x16_bf16 v[56:59], v[52:53], v[54:55], v[56:59]
    s_nop 9
    v_cvt_pk_bf16_f32 v60, v56, v57
    v_cvt_pk_bf16_f32 v61, v58, v59
    v_lshlrev_b32 v56, 16, v60
    v_and_b32 v57, 0xffff0000, v60
    v_lshlrev_b32 v58, 16, v61
    v_and_b32 v59, 0xffff0000, v61
    v_max_f32 v64, v56, v57
    v_max3_f32 v64, v64, v58, v59
    v_min_f32 v65, v56, v57
    v_min3_f32 v65, v65, v58, v59
    v_mov_b32 v66, v64
    s_nop 1
    v_permlane16_swap_b32 v64, v66
    s_nop 0
    v_max_f32 v64, v64, v66
    v_mov_b32 v66, v64
    s_nop 1
    v_permlane32_swap_b32 v64, v66
    s_nop 0
    v_max_f32 v64, v64, v66
    v_mov_b32 v66, v65
    s_nop 1
    v_permlane16_swap_b32 v65, v66
    s_nop 0
    v_min_f32 v65, v65, v66
    v_mov_b32 v66, v65
    s_nop 1
    v_permlane32_swap_b32 v65, v66
    s_nop 0
    v_min_f32 v65, v65, v66
    v_sub_f32 v72, v56, v64
    v_sub_f32 v76, v65, v56
    v_sub_f32 v73, v57, v64
    v_sub_f32 v77, v65, v57
    v_sub_f32 v74, v58, v64
    v_sub_f32 v78, v65, v58
    v_sub_f32 v75, v59, v64
    v_sub_f32 v79, v65, v59
    v_mul_f32 v72, 0x3fb8aa3b, v72
    v_mul_f32 v73, 0x3fb8aa3b, v73
    v_mul_f32 v74, 0x3fb8aa3b, v74
    v_mul_f32 v75, 0x3fb8aa3b, v75
    v_mul_f32 v76, 0x3fb8aa3b, v76
    v_mul_f32 v77, 0x3fb8aa3b, v77
    v_mul_f32 v78, 0x3fb8aa3b, v78
    v_mul_f32 v79, 0x3fb8aa3b, v79
    v_exp_f32 v72, v72
    v_exp_f32 v73, v73
    v_exp_f32 v74, v74
    v_exp_f32 v75, v75
    v_exp_f32 v76, v76
    v_exp_f32 v77, v77
    v_exp_f32 v78, v78
    v_exp_f32 v79, v79
    s_nop 0
    v_add_f32 v64, v72, v73
    v_add_f32 v64, v64, v74
    v_add_f32 v64, v64, v75
    v_add_f32 v65, v76, v77
    v_add_f32 v65, v65, v78
    v_add_f32 v65, v65, v79
    v_mov_b32 v66, v64
    s_nop 1
    v_permlane16_swap_b32 v64, v66
    s_nop 0
    v_add_f32 v64, v64, v66
    v_mov_b32 v66, v64
    s_nop 1
    v_permlane32_swap_b32 v64, v66
    s_nop 0
    v_add_f32 v64, v64, v66
    v_mov_b32 v66, v65
    s_nop 1
    v_permlane16_swap_b32 v65, v66
    s_nop 0
    v_add_f32 v65, v65, v66
    v_mov_b32 v66, v65
    s_nop 1
    v_permlane32_swap_b32 v65, v66
    s_nop 0
    v_add_f32 v65, v65, v66
    v_rcp_f32 v64, v64
    v_rcp_f32 v65, v65
    s_nop 0
    v_mul_f32 v72, v72, v64
    v_mul_f32 v76, v76, v65
    v_mul_f32 v73, v73, v64
    v_mul_f32 v77, v77, v65
    v_mul_f32 v74, v74, v64
    v_mul_f32 v78, v78, v65
    v_mul_f32 v75, v75, v64
    v_mul_f32 v79, v79, v65
    v_cvt_pk_bf16_f32 v84, v72, v73
    v_cvt_pk_bf16_f32 v85, v74, v75
    v_cvt_pk_bf16_f32 v86, v76, v77
    v_cvt_pk_bf16_f32 v87, v78, v79
    v_lshlrev_b32 v48, 4, v1
    global_store_dwordx4 v48, v[84:87], s[32:33] offset:0
    s_nop 1
    v_cvt_pk_bf16_f32 v54, v28, v29
    v_cvt_pk_bf16_f32 v55, v30, v31
    v_mov_b32 v56, 0
    v_mov_b32 v57, 0
    v_mov_b32 v58, 0
    v_mov_b32 v59, 0
    s_nop 1
    v_mfma_f32_16x16x16_bf16 v[56:59], v[52:53], v[54:55], v[56:59]
    s_nop 9
    v_cvt_pk_bf16_f32 v60, v56, v57
    v_cvt_pk_bf16_f32 v61, v58, v59
    v_lshlrev_b32 v56, 16, v60
    v_and_b32 v57, 0xffff0000, v60
    v_lshlrev_b32 v58, 16, v61
    v_and_b32 v59, 0xffff0000, v61
    v_max_f32 v64, v56, v57
    v_max3_f32 v64, v64, v58, v59
    v_min_f32 v65, v56, v57
    v_min3_f32 v65, v65, v58, v59
    v_mov_b32 v66, v64
    s_nop 1
    v_permlane16_swap_b32 v64, v66
    s_nop 0
    v_max_f32 v64, v64, v66
    v_mov_b32 v66, v64
    s_nop 1
    v_permlane32_swap_b32 v64, v66
    s_nop 0
    v_max_f32 v64, v64, v66
    v_mov_b32 v66, v65
    s_nop 1
    v_permlane16_swap_b32 v65, v66
    s_nop 0
    v_min_f32 v65, v65, v66
    v_mov_b32 v66, v65
    s_nop 1
    v_permlane32_swap_b32 v65, v66
    s_nop 0
    v_min_f32 v65, v65, v66
    v_sub_f32 v72, v56, v64
    v_sub_f32 v76, v65, v56
    v_sub_f32 v73, v57, v64
    v_sub_f32 v77, v65, v57
    v_sub_f32 v74, v58, v64
    v_sub_f32 v78, v65, v58
    v_sub_f32 v75, v59, v64
    v_sub_f32 v79, v65, v59
    v_mul_f32 v72, 0x3fb8aa3b, v72
    v_mul_f32 v73, 0x3fb8aa3b, v73
    v_mul_f32 v74, 0x3fb8aa3b, v74
    v_mul_f32 v75, 0x3fb8aa3b, v75
    v_mul_f32 v76, 0x3fb8aa3b, v76
    v_mul_f32 v77, 0x3fb8aa3b, v77
    v_mul_f32 v78, 0x3fb8aa3b, v78
    v_mul_f32 v79, 0x3fb8aa3b, v79
    v_exp_f32 v72, v72
    v_exp_f32 v73, v73
    v_exp_f32 v74, v74
    v_exp_f32 v75, v75
    v_exp_f32 v76, v76
    v_exp_f32 v77, v77
    v_exp_f32 v78, v78
    v_exp_f32 v79, v79
    s_nop 0
    v_add_f32 v64, v72, v73
    v_add_f32 v64, v64, v74
    v_add_f32 v64, v64, v75
    v_add_f32 v65, v76, v77
    v_add_f32 v65, v65, v78
    v_add_f32 v65, v65, v79
    v_mov_b32 v66, v64
    s_nop 1
    v_permlane16_swap_b32 v64, v66
    s_nop 0
    v_add_f32 v64, v64, v66
    v_mov_b32 v66, v64
    s_nop 1
    v_permlane32_swap_b32 v64, v66
    s_nop 0
    v_add_f32 v64, v64, v66
    v_mov_b32 v66, v65
    s_nop 1
    v_permlane16_swap_b32 v65, v66
    s_nop 0
    v_add_f32 v65, v65, v66
    v_mov_b32 v66, v65
    s_nop 1
    v_permlane32_swap_b32 v65, v66
    s_nop 0
    v_add_f32 v65, v65, v66
    v_rcp_f32 v64, v64
    v_rcp_f32 v65, v65
    s_nop 0
    v_mul_f32 v72, v72, v64
    v_mul_f32 v76, v76, v65
    v_mul_f32 v73, v73, v64
    v_mul_f32 v77, v77, v65
    v_mul_f32 v74, v74, v64
    v_mul_f32 v78, v78, v65
    v_mul_f32 v75, v75, v64
    v_mul_f32 v79, v79, v65
    v_cvt_pk_bf16_f32 v84, v72, v73
    v_cvt_pk_bf16_f32 v85, v74, v75
    v_cvt_pk_bf16_f32 v86, v76, v77
    v_cvt_pk_bf16_f32 v87, v78, v79
    v_lshlrev_b32 v48, 4, v1
    global_store_dwordx4 v48, v[84:87], s[32:33] offset:1024
    s_nop 1
    s_branch L1_next
L1_ep_mlp:
    s_lshl_b32 s31, s14, 3
    s_lshl_b32 s34, s17, 1
    s_add_u32 s31, s31, s34
    s_mul_i32 s31, s31, 56
    s_add_u32 s31, s31, s19
    s_sub_u32 s31, s31, 24
    s_lshl_b32 s31, s31, 10
    s_lshl_b32 s34, s18, 3
    s_add_u32 s31, s31, s34
    s_add_u32 s31, s31, 2097152
    s_add_u32 s32, s12, s31
    s_addc_u32 s33, s13, 0
    v_lshlrev_b32 v48, 4, v1
    v_max_f32 v56, 0, v16
    v_max_f32 v57, 0, v17
    v_max_f32 v58, 0, v18
    v_max_f32 v59, 0, v19
    v_cvt_pk_bf16_f32 v60, v56, v57
    v_cvt_pk_bf16_f32 v61, v58, v59
    v_lshlrev_b32 v56, 16, v60
    v_and_b32 v57, 0xffff0000, v60
    v_lshlrev_b32 v58, 16, v61
    v_and_b32 v59, 0xffff0000, v61
    v_cvt_pk_bf16_f32 v60, v20, v21
    v_cvt_pk_bf16_f32 v61, v22, v23
    v_lshlrev_b32 v20, 16, v60
    v_and_b32 v21, 0xffff0000, v60
    v_lshlrev_b32 v22, 16, v61
    v_and_b32 v23, 0xffff0000, v61
    v_mul_f32 v56, v56, v20
    v_mul_f32 v57, v57, v21
    v_mul_f32 v58, v58, v22
    v_mul_f32 v59, v59, v23
    v_cvt_pk_bf16_f32 v84, v56, v57
    v_cvt_pk_bf16_f32 v85, v58, v59
    global_store_dwordx2 v48, v[84:85], s[32:33]
    s_nop 1
    v_max_f32 v56, 0, v24
    v_max_f32 v57, 0, v25
    v_max_f32 v58, 0, v26
    v_max_f32 v59, 0, v27
    v_cvt_pk_bf16_f32 v60, v56, v57
    v_cvt_pk_bf16_f32 v61, v58, v59
    v_lshlrev_b32 v56, 16, v60
    v_and_b32 v57, 0xffff0000, v60
    v_lshlrev_b32 v58, 16, v61
    v_and_b32 v59, 0xffff0000, v61
    v_cvt_pk_bf16_f32 v60, v28, v29
    v_cvt_pk_bf16_f32 v61, v30, v31
    v_lshlrev_b32 v28, 16, v60
    v_and_b32 v29, 0xffff0000, v60
    v_lshlrev_b32 v30, 16, v61
    v_and_b32 v31, 0xffff0000, v61
    v_mul_f32 v56, v56, v28
    v_mul_f32 v57, v57, v29
    v_mul_f32 v58, v58, v30
    v_mul_f32 v59, v59, v31
    v_cvt_pk_bf16_f32 v84, v56, v57
    v_cvt_pk_bf16_f32 v85, v58, v59
    s_add_u32 s32, s32, 57344
    s_addc_u32 s33, s33, 0
    global_store_dwordx2 v48, v[84:85], s[32:33]
    s_nop 1
L1_next:
    v_xor_b32 v4, 0x10000, v4
    v_xor_b32 v5, 0x10000, v5
    s_xor_b32 s30, s30, 0x10000
    s_add_u32 s19, s19, 16
    s_add_u32 s20, s20, 1
    s_cmp_lt_u32 s20, 5
    s_cbranch_scc1 L1_loop
L1_end:
    s_endpgm
.globl gemm2_kernel
.p2align 8
.type gemm2_kernel,@function
gemm2_kernel:
    s_cmp_ge_u32 s2, 256
    s_cbranch_scc1 L2_end
    s_load_dwordx2 s[4:5], s[0:1], 0
    s_load_dwordx2 s[6:7], s[0:1], 24
    s_load_dwordx2 s[8:9], s[0:1], 56
    s_load_dwordx2 s[10:11], s[0:1], 64
    s_load_dwordx2 s[12:13], s[0:1], 80
    v_and_b32 v1, 63, v0
    v_lshrrev_b32 v6, 6, v0
    s_nop 0
    v_readfirstlane_b32 s16, v6
    s_lshr_b32 s14, s2, 6
    s_lshl_b32 s14, s14, 3
    s_and_b32 s31, s2, 7
    s_add_u32 s14, s14, s31
    s_bfe_u32 s15, s2, 0x30003
    s_mul_i32 s17, s16, 12288
    v_bfe_u32 v6, v1, 1, 2
    v_bfe_u32 v7, v1, 4, 2
    v_xor_b32 v6, v6, v7
    v_lshlrev_b32 v2, 5, v6
    v_lshrrev_b32 v7, 3, v1
    v_lshl_add_u32 v2, v7, 10, v2
    v_and_b32 v7, 1, v1
    v_lshl_add_u32 v2, v7, 4, v2
    s_lshl_b32 s31, s15, 7
    v_add_u32 v2, s31, v2
    v_lshrrev_b32 v6, 4, v1
    v_bfe_u32 v7, v1, 2, 2
    v_lshl_add_u32 v12, v6, 2, v7
    v_lshlrev_b32 v12, 7, v12
    v_and_b32 v13, 3, v1
    v_lshl_add_u32 v12, v13, 3, v12
    v_add_u32 v12, s17, v12
    v_lshrrev_b32 v13, 1, v7
    v_lshl_add_u32 v13, v6, 1, v13
    v_and_b32 v13, 3, v13
    v_xor_b32 v14, 0, v13
    v_lshl_add_u32 v8, v14, 5, v12
    v_xor_b32 v14, 1, v13
    v_lshl_add_u32 v9, v14, 5, v12
    v_xor_b32 v14, 2, v13
    v_lshl_add_u32 v10, v14, 5, v12
    v_xor_b32 v14, 3, v13
    v_lshl_add_u32 v11, v14, 5, v12
    v_lshlrev_b32 v3, 4, v1
    v_lshlrev_b32 v4, 2, v1
    v_mov_b32 v192, 0
    v_mov_b32 v193, 0
    v_mov_b32 v194, 0
    v_mov_b32 v195, 0
    v_mov_b32 v196, 0
    v_mov_b32 v197, 0
    v_mov_b32 v198, 0
    v_mov_b32 v199, 0
    v_mov_b32 v200, 0
    v_mov_b32 v201, 0
    v_mov_b32 v202, 0
    v_mov_b32 v203, 0
    v_mov_b32 v204, 0
    v_mov_b32 v205, 0
    v_mov_b32 v206, 0
    v_mov_b32 v207, 0
    v_mov_b32 v208, 0
    v_mov_b32 v209, 0
    v_mov_b32 v210, 0
    v_mov_b32 v211, 0
    v_mov_b32 v212, 0
    v_mov_b32 v213, 0
    v_mov_b32 v214, 0
    v_mov_b32 v215, 0
    v_mov_b32 v216, 0
    v_mov_b32 v217, 0
    v_mov_b32 v218, 0
    v_mov_b32 v219, 0
    v_mov_b32 v220, 0
    v_mov_b32 v221, 0
    v_mov_b32 v222, 0
    v_mov_b32 v223, 0
    v_mov_b32 v224, 0
    v_mov_b32 v225, 0
    v_mov_b32 v226, 0
    v_mov_b32 v227, 0
    v_mov_b32 v228, 0
    v_mov_b32 v229, 0
    v_mov_b32 v230, 0
    v_mov_b32 v231, 0
    v_mov_b32 v232, 0
    v_mov_b32 v233, 0
    v_mov_b32 v234, 0
    v_mov_b32 v235, 0
    v_mov_b32 v236, 0
    v_mov_b32 v237, 0
    v_mov_b32 v238, 0
    v_mov_b32 v239, 0
    v_mov_b32 v240, 0
    v_mov_b32 v241, 0
    v_mov_b32 v242, 0
    v_mov_b32 v243, 0
    v_mov_b32 v244, 0
    v_mov_b32 v245, 0
    v_mov_b32 v246, 0
    v_mov_b32 v247, 0
    v_mov_b32 v248, 0
    v_mov_b32 v249, 0
    v_mov_b32 v250, 0
    v_mov_b32 v251, 0
    v_mov_b32 v252, 0
    v_mov_b32 v253, 0
    v_mov_b32 v254, 0
    v_mov_b32 v255, 0
    s_waitcnt lgkmcnt(0)
    s_mul_i32 s20, s16, 7
    s_lshl_b32 s22, s14, 2
    s_mul_i32 s22, s22, 56
    s_add_u32 s22, s22, s20
    s_lshl_b32 s22, s22, 10
    s_add_u32 s22, s22, 2097152
    s_add_u32 s24, s12, s22
    s_addc_u32 s25, s13, 0
    s_lshl_b32 s20, s16, 1
    s_lshl_b32 s31, s20, 15
    s_add_u32 s32, s6, s31
    s_addc_u32 s33, s7, 0
    s_add_u32 s34, s17, 8192
    s_mov_b32 m0, s34
    s_nop 0
    global_load_lds_dwordx4 v2, s[32:33]
    s_add_u32 s34, s34, 1024
    s_add_u32 s32, s32, 8192
    s_addc_u32 s33, s33, 0
    s_mov_b32 m0, s34
    s_nop 0
    global_load_lds_dwordx4 v2, s[32:33]
    s_add_u32 s34, s34, 1024
    s_add_u32 s32, s32, 8192
    s_addc_u32 s33, s33, 0
    s_mov_b32 m0, s34
    s_nop 0
    global_load_lds_dwordx4 v2, s[32:33]
    s_add_u32 s34, s34, 1024
    s_add_u32 s32, s32, 8192
    s_addc_u32 s33, s33, 0
    s_mov_b32 m0, s34
    s_nop 0
    global_load_lds_dwordx4 v2, s[32:33]
    s_lshl_b32 s21, s20, 1
    s_lshl_b32 s31, s21, 11
    s_add_u32 s31, s31, 13631488
    s_add_u32 s32, s12, s31
    s_addc_u32 s33, s13, 0
    global_load_dword v20, v4, s[32:33] offset:0
    global_load_dword v21, v4, s[32:33] offset:256
    global_load_dword v22, v4, s[32:33] offset:512
    global_load_dword v23, v4, s[32:33] offset:768
    global_load_dword v24, v4, s[32:33] offset:1024
    global_load_dword v25, v4, s[32:33] offset:1280
    global_load_dword v26, v4, s[32:33] offset:1536
    global_load_dword v27, v4, s[32:33] offset:1792
    s_add_u32 s32, s32, 65536
    s_addc_u32 s33, s33, 0
    global_load_dword v28, v4, s[32:33] offset:0
    global_load_dword v29, v4, s[32:33] offset:256
    global_load_dword v30, v4, s[32:33] offset:512
    global_load_dword v31, v4, s[32:33] offset:768
    global_load_dword v32, v4, s[32:33] offset:1024
    global_load_dword v33, v4, s[32:33] offset:1280
    global_load_dword v34, v4, s[32:33] offset:1536
    global_load_dword v35, v4, s[32:33] offset:1792
    s_lshl_b32 s31, s21, 7
    s_lshl_b32 s34, s14, 2
    s_add_u32 s31, s31, s34
    s_lshl_b32 s31, s31, 10
    s_add_u32 s31, s31, 9437184
    s_add_u32 s32, s12, s31
    s_addc_u32 s33, s13, 0
    global_load_dwordx4 v[52:55], v3, s[32:33] offset:0
    global_load_dwordx4 v[56:59], v3, s[32:33] offset:1024
    global_load_dwordx4 v[60:63], v3, s[32:33] offset:2048
    global_load_dwordx4 v[64:67], v3, s[32:33] offset:3072
    s_lshl_b32 s21, s20, 1
    s_add_u32 s21, s21, 1
    s_lshl_b32 s31, s21, 11
    s_add_u32 s31, s31, 13631488
    s_add_u32 s32, s12, s31
    s_addc_u32 s33, s13, 0
    global_load_dword v36, v4, s[32:33] offset:0
    global_load_dword v37, v4, s[32:33] offset:256
    global_load_dword v38, v4, s[32:33] offset:512
    global_load_dword v39, v4, s[32:33] offset:768
    global_load_dword v40, v4, s[32:33] offset:1024
    global_load_dword v41, v4, s[32:33] offset:1280
    global_load_dword v42, v4, s[32:33] offset:1536
    global_load_dword v43, v4, s[32:33] offset:1792
    s_add_u32 s32, s32, 65536
    s_addc_u32 s33, s33, 0
    global_load_dword v44, v4, s[32:33] offset:0
    global_load_dword v45, v4, s[32:33] offset:256
    global_load_dword v46, v4, s[32:33] offset:512
    global_load_dword v47, v4, s[32:33] offset:768
    global_load_dword v48, v4, s[32:33] offset:1024
    global_load_dword v49, v4, s[32:33] offset:1280
    global_load_dword v50, v4, s[32:33] offset:1536
    global_load_dword v51, v4, s[32:33] offset:1792
    s_lshl_b32 s31, s21, 7
    s_lshl_b32 s34, s14, 2
    s_add_u32 s31, s31, s34
    s_lshl_b32 s31, s31, 10
    s_add_u32 s31, s31, 9437184
    s_add_u32 s32, s12, s31
    s_addc_u32 s33, s13, 0
    global_load_dwordx4 v[68:71], v3, s[32:33] offset:0
    global_load_dwordx4 v[72:75], v3, s[32:33] offset:1024
    global_load_dwordx4 v[76:79], v3, s[32:33] offset:2048
    global_load_dwordx4 v[80:83], v3, s[32:33] offset:3072
    s_waitcnt vmcnt(0)
    v_cvt_pk_bf16_f32 v84, v20, v21
    v_cvt_pk_bf16_f32 v88, v28, v29
    v_cvt_pk_bf16_f32 v85, v22, v23
    v_cvt_pk_bf16_f32 v89, v30, v31
    v_cvt_pk_bf16_f32 v86, v24, v25
    v_cvt_pk_bf16_f32 v90, v32, v33
    v_cvt_pk_bf16_f32 v87, v26, v27
    v_cvt_pk_bf16_f32 v91, v34, v35
    v_mov_b32 v160, 0
    v_mov_b32 v161, 0
    v_mov_b32 v162, 0
    v_mov_b32 v163, 0
    v_mov_b32 v164, 0
    v_mov_b32 v165, 0
    v_mov_b32 v166, 0
    v_mov_b32 v167, 0
    v_mov_b32 v168, 0
    v_mov_b32 v169, 0
    v_mov_b32 v170, 0
    v_mov_b32 v171, 0
    v_mov_b32 v172, 0
    v_mov_b32 v173, 0
    v_mov_b32 v174, 0
    v_mov_b32 v175, 0
    v_mov_b32 v176, 0
    v_mov_b32 v177, 0
    v_mov_b32 v178, 0
    v_mov_b32 v179, 0
    v_mov_b32 v180, 0
    v_mov_b32 v181, 0
    v_mov_b32 v182, 0
    v_mov_b32 v183, 0
    v_mov_b32 v184, 0
    v_mov_b32 v185, 0
    v_mov_b32 v186, 0
    v_mov_b32 v187, 0
    v_mov_b32 v188, 0
    v_mov_b32 v189, 0
    v_mov_b32 v190, 0
    v_mov_b32 v191, 0
    s_nop 1
    v_mfma_f32_16x16x32_bf16 v[160:163], v[84:87], v[52:55], v[160:163]
    v_mfma_f32_16x16x32_bf16 v[164:167], v[88:91], v[52:55], v[164:167]
    v_mfma_f32_16x16x32_bf16 v[168:171], v[84:87], v[56:59], v[168:171]
    v_mfma_f32_16x16x32_bf16 v[172:175], v[88:91], v[56:59], v[172:175]
    v_mfma_f32_16x16x32_bf16 v[176:179], v[84:87], v[60:63], v[176:179]
    v_mfma_f32_16x16x32_bf16 v[180:183], v[88:91], v[60:63], v[180:183]
    v_mfma_f32_16x16x32_bf16 v[184:187], v[84:87], v[64:67], v[184:187]
    v_mfma_f32_16x16x32_bf16 v[188:191], v[88:91], v[64:67], v[188:191]
    s_nop 9
    v_add_f32 v164, 0x358637bd, v164
    v_rcp_f32 v164, v164
    v_add_f32 v172, 0x358637bd, v172
    v_rcp_f32 v172, v172
    v_add_f32 v180, 0x358637bd, v180
    v_rcp_f32 v180, v180
    v_add_f32 v188, 0x358637bd, v188
    v_rcp_f32 v188, v188
    s_nop 0
    v_mul_f32 v160, v160, v164
    v_mul_f32 v161, v161, v164
    v_mul_f32 v162, v162, v164
    v_mul_f32 v163, v163, v164
    v_cvt_pk_bf16_f32 v128, v160, v161
    v_cvt_pk_bf16_f32 v129, v162, v163
    v_mul_f32 v168, v168, v172
    v_mul_f32 v169, v169, v172
    v_mul_f32 v170, v170, v172
    v_mul_f32 v171, v171, v172
    v_cvt_pk_bf16_f32 v132, v168, v169
    v_cvt_pk_bf16_f32 v133, v170, v171
    v_mul_f32 v176, v176, v180
    v_mul_f32 v177, v177, v180
    v_mul_f32 v178, v178, v180
    v_mul_f32 v179, v179, v180
    v_cvt_pk_bf16_f32 v136, v176, v177
    v_cvt_pk_bf16_f32 v137, v178, v179
    v_mul_f32 v184, v184, v188
    v_mul_f32 v185, v185, v188
    v_mul_f32 v186, v186, v188
    v_mul_f32 v187, v187, v188
    v_cvt_pk_bf16_f32 v140, v184, v185
    v_cvt_pk_bf16_f32 v141, v186, v187
    v_cvt_pk_bf16_f32 v84, v36, v37
    v_cvt_pk_bf16_f32 v88, v44, v45
    v_cvt_pk_bf16_f32 v85, v38, v39
    v_cvt_pk_bf16_f32 v89, v46, v47
    v_cvt_pk_bf16_f32 v86, v40, v41
    v_cvt_pk_bf16_f32 v90, v48, v49
    v_cvt_pk_bf16_f32 v87, v42, v43
    v_cvt_pk_bf16_f32 v91, v50, v51
    v_mov_b32 v160, 0
    v_mov_b32 v161, 0
    v_mov_b32 v162, 0
    v_mov_b32 v163, 0
    v_mov_b32 v164, 0
    v_mov_b32 v165, 0
    v_mov_b32 v166, 0
    v_mov_b32 v167, 0
    v_mov_b32 v168, 0
    v_mov_b32 v169, 0
    v_mov_b32 v170, 0
    v_mov_b32 v171, 0
    v_mov_b32 v172, 0
    v_mov_b32 v173, 0
    v_mov_b32 v174, 0
    v_mov_b32 v175, 0
    v_mov_b32 v176, 0
    v_mov_b32 v177, 0
    v_mov_b32 v178, 0
    v_mov_b32 v179, 0
    v_mov_b32 v180, 0
    v_mov_b32 v181, 0
    v_mov_b32 v182, 0
    v_mov_b32 v183, 0
    v_mov_b32 v184, 0
    v_mov_b32 v185, 0
    v_mov_b32 v186, 0
    v_mov_b32 v187, 0
    v_mov_b32 v188, 0
    v_mov_b32 v189, 0
    v_mov_b32 v190, 0
    v_mov_b32 v191, 0
    s_nop 1
    v_mfma_f32_16x16x32_bf16 v[160:163], v[84:87], v[68:71], v[160:163]
    v_mfma_f32_16x16x32_bf16 v[164:167], v[88:91], v[68:71], v[164:167]
    v_mfma_f32_16x16x32_bf16 v[168:171], v[84:87], v[72:75], v[168:171]
    v_mfma_f32_16x16x32_bf16 v[172:175], v[88:91], v[72:75], v[172:175]
    v_mfma_f32_16x16x32_bf16 v[176:179], v[84:87], v[76:79], v[176:179]
    v_mfma_f32_16x16x32_bf16 v[180:183], v[88:91], v[76:79], v[180:183]
    v_mfma_f32_16x16x32_bf16 v[184:187], v[84:87], v[80:83], v[184:187]
    v_mfma_f32_16x16x32_bf16 v[188:191], v[88:91], v[80:83], v[188:191]
    s_nop 9
    v_add_f32 v164, 0x358637bd, v164
    v_rcp_f32 v164, v164
    v_add_f32 v172, 0x358637bd, v172
    v_rcp_f32 v172, v172
    v_add_f32 v180, 0x358637bd, v180
    v_rcp_f32 v180, v180
    v_add_f32 v188, 0x358637bd, v188
    v_rcp_f32 v188, v188
    s_nop 0
    v_mul_f32 v160, v160, v164
    v_mul_f32 v161, v161, v164
    v_mul_f32 v162, v162, v164
    v_mul_f32 v163, v163, v164
    v_cvt_pk_bf16_f32 v130, v160, v161
    v_cvt_pk_bf16_f32 v131, v162, v163
    v_mul_f32 v168, v168, v172
    v_mul_f32 v169, v169, v172
    v_mul_f32 v170, v170, v172
    v_mul_f32 v171, v171, v172
    v_cvt_pk_bf16_f32 v134, v168, v169
    v_cvt_pk_bf16_f32 v135, v170, v171
    v_mul_f32 v176, v176, v180
    v_mul_f32 v177, v177, v180
    v_mul_f32 v178, v178, v180
    v_mul_f32 v179, v179, v180
    v_cvt_pk_bf16_f32 v138, v176, v177
    v_cvt_pk_bf16_f32 v139, v178, v179
    v_mul_f32 v184, v184, v188
    v_mul_f32 v185, v185, v188
    v_mul_f32 v186, v186, v188
    v_mul_f32 v187, v187, v188
    v_cvt_pk_bf16_f32 v142, v184, v185
    v_cvt_pk_bf16_f32 v143, v186, v187
    ds_read_b64_tr_b16 v[144:145], v8 offset:8192
    ds_read_b64_tr_b16 v[146:147], v8 offset:10240
    ds_read_b64_tr_b16 v[148:149], v9 offset:8192
    ds_read_b64_tr_b16 v[150:151], v9 offset:10240
    ds_read_b64_tr_b16 v[152:153], v10 offset:8192
    ds_read_b64_tr_b16 v[154:155], v10 offset:10240
    ds_read_b64_tr_b16 v[156:157], v11 offset:8192
    ds_read_b64_tr_b16 v[158:159], v11 offset:10240
    s_waitcnt lgkmcnt(0)
    v_mfma_f32_16x16x32_bf16 v[192:195], v[144:147], v[128:131], v[192:195]
    v_mfma_f32_16x16x32_bf16 v[196:199], v[148:151], v[128:131], v[196:199]
    v_mfma_f32_16x16x32_bf16 v[200:203], v[152:155], v[128:131], v[200:203]
    v_mfma_f32_16x16x32_bf16 v[204:207], v[156:159], v[128:131], v[204:207]
    v_mfma_f32_16x16x32_bf16 v[208:211], v[144:147], v[132:135], v[208:211]
    v_mfma_f32_16x16x32_bf16 v[212:215], v[148:151], v[132:135], v[212:215]
    v_mfma_f32_16x16x32_bf16 v[216:219], v[152:155], v[132:135], v[216:219]
    v_mfma_f32_16x16x32_bf16 v[220:223], v[156:159], v[132:135], v[220:223]
    v_mfma_f32_16x16x32_bf16 v[224:227], v[144:147], v[136:139], v[224:227]
    v_mfma_f32_16x16x32_bf16 v[228:231], v[148:151], v[136:139], v[228:231]
    v_mfma_f32_16x16x32_bf16 v[232:235], v[152:155], v[136:139], v[232:235]
    v_mfma_f32_16x16x32_bf16 v[236:239], v[156:159], v[136:139], v[236:239]
    v_mfma_f32_16x16x32_bf16 v[240:243], v[144:147], v[140:143], v[240:243]
    v_mfma_f32_16x16x32_bf16 v[244:247], v[148:151], v[140:143], v[244:247]
    v_mfma_f32_16x16x32_bf16 v[248:251], v[152:155], v[140:143], v[248:251]
    v_mfma_f32_16x16x32_bf16 v[252:255], v[156:159], v[140:143], v[252:255]
    s_nop 1
    s_lshl_b32 s20, s16, 1
    s_add_u32 s20, s20, 1
    s_lshl_b32 s31, s20, 15
    s_add_u32 s32, s6, s31
    s_addc_u32 s33, s7, 0
    s_add_u32 s34, s17, 8192
    s_mov_b32 m0, s34
    s_nop 0
    global_load_lds_dwordx4 v2, s[32:33]
    s_add_u32 s34, s34, 1024
    s_add_u32 s32, s32, 8192
    s_addc_u32 s33, s33, 0
    s_mov_b32 m0, s34
    s_nop 0
    global_load_lds_dwordx4 v2, s[32:33]
    s_add_u32 s34, s34, 1024
    s_add_u32 s32, s32, 8192
    s_addc_u32 s33, s33, 0
    s_mov_b32 m0, s34
    s_nop 0
    global_load_lds_dwordx4 v2, s[32:33]
    s_add_u32 s34, s34, 1024
    s_add_u32 s32, s32, 8192
    s_addc_u32 s33, s33, 0
    s_mov_b32 m0, s34
    s_nop 0
    global_load_lds_dwordx4 v2, s[32:33]
    s_lshl_b32 s21, s20, 1
    s_lshl_b32 s31, s21, 11
    s_add_u32 s31, s31, 13631488
    s_add_u32 s32, s12, s31
    s_addc_u32 s33, s13, 0
    global_load_dword v20, v4, s[32:33] offset:0
    global_load_dword v21, v4, s[32:33] offset:256
    global_load_dword v22, v4, s[32:33] offset:512
    global_load_dword v23, v4, s[32:33] offset:768
    global_load_dword v24, v4, s[32:33] offset:1024
    global_load_dword v25, v4, s[32:33] offset:1280
    global_load_dword v26, v4, s[32:33] offset:1536
    global_load_dword v27, v4, s[32:33] offset:1792
    s_add_u32 s32, s32, 65536
    s_addc_u32 s33, s33, 0
    global_load_dword v28, v4, s[32:33] offset:0
    global_load_dword v29, v4, s[32:33] offset:256
    global_load_dword v30, v4, s[32:33] offset:512
    global_load_dword v31, v4, s[32:33] offset:768
    global_load_dword v32, v4, s[32:33] offset:1024
    global_load_dword v33, v4, s[32:33] offset:1280
    global_load_dword v34, v4, s[32:33] offset:1536
    global_load_dword v35, v4, s[32:33] offset:1792
    s_lshl_b32 s31, s21, 7
    s_lshl_b32 s34, s14, 2
    s_add_u32 s31, s31, s34
    s_lshl_b32 s31, s31, 10
    s_add_u32 s31, s31, 9437184
    s_add_u32 s32, s12, s31
    s_addc_u32 s33, s13, 0
    global_load_dwordx4 v[52:55], v3, s[32:33] offset:0
    global_load_dwordx4 v[56:59], v3, s[32:33] offset:1024
    global_load_dwordx4 v[60:63], v3, s[32:33] offset:2048
    global_load_dwordx4 v[64:67], v3, s[32:33] offset:3072
    s_lshl_b32 s21, s20, 1
    s_add_u32 s21, s21, 1
    s_lshl_b32 s31, s21, 11
    s_add_u32 s31, s31, 13631488
    s_add_u32 s32, s12, s31
    s_addc_u32 s33, s13, 0
    global_load_dword v36, v4, s[32:33] offset:0
    global_load_dword v37, v4, s[32:33] offset:256
    global_load_dword v38, v4, s[32:33] offset:512
    global_load_dword v39, v4, s[32:33] offset:768
    global_load_dword v40, v4, s[32:33] offset:1024
    global_load_dword v41, v4, s[32:33] offset:1280
    global_load_dword v42, v4, s[32:33] offset:1536
    global_load_dword v43, v4, s[32:33] offset:1792
    s_add_u32 s32, s32, 65536
    s_addc_u32 s33, s33, 0
    global_load_dword v44, v4, s[32:33] offset:0
    global_load_dword v45, v4, s[32:33] offset:256
    global_load_dword v46, v4, s[32:33] offset:512
    global_load_dword v47, v4, s[32:33] offset:768
    global_load_dword v48, v4, s[32:33] offset:1024
    global_load_dword v49, v4, s[32:33] offset:1280
    global_load_dword v50, v4, s[32:33] offset:1536
    global_load_dword v51, v4, s[32:33] offset:1792
    s_lshl_b32 s31, s21, 7
    s_lshl_b32 s34, s14, 2
    s_add_u32 s31, s31, s34
    s_lshl_b32 s31, s31, 10
    s_add_u32 s31, s31, 9437184
    s_add_u32 s32, s12, s31
    s_addc_u32 s33, s13, 0
    global_load_dwordx4 v[68:71], v3, s[32:33] offset:0
    global_load_dwordx4 v[72:75], v3, s[32:33] offset:1024
    global_load_dwordx4 v[76:79], v3, s[32:33] offset:2048
    global_load_dwordx4 v[80:83], v3, s[32:33] offset:3072
    s_waitcnt vmcnt(0)
    v_cvt_pk_bf16_f32 v84, v20, v21
    v_cvt_pk_bf16_f32 v88, v28, v29
    v_cvt_pk_bf16_f32 v85, v22, v23
    v_cvt_pk_bf16_f32 v89, v30, v31
    v_cvt_pk_bf16_f32 v86, v24, v25
    v_cvt_pk_bf16_f32 v90, v32, v33
    v_cvt_pk_bf16_f32 v87, v26, v27
    v_cvt_pk_bf16_f32 v91, v34, v35
    v_mov_b32 v160, 0
    v_mov_b32 v161, 0
    v_mov_b32 v162, 0
    v_mov_b32 v163, 0
    v_mov_b32 v164, 0
    v_mov_b32 v165, 0
    v_mov_b32 v166, 0
    v_mov_b32 v167, 0
    v_mov_b32 v168, 0
    v_mov_b32 v169, 0
    v_mov_b32 v170, 0
    v_mov_b32 v171, 0
    v_mov_b32 v172, 0
    v_mov_b32 v173, 0
    v_mov_b32 v174, 0
    v_mov_b32 v175, 0
    v_mov_b32 v176, 0
    v_mov_b32 v177, 0
    v_mov_b32 v178, 0
    v_mov_b32 v179, 0
    v_mov_b32 v180, 0
    v_mov_b32 v181, 0
    v_mov_b32 v182, 0
    v_mov_b32 v183, 0
    v_mov_b32 v184, 0
    v_mov_b32 v185, 0
    v_mov_b32 v186, 0
    v_mov_b32 v187, 0
    v_mov_b32 v188, 0
    v_mov_b32 v189, 0
    v_mov_b32 v190, 0
    v_mov_b32 v191, 0
    s_nop 1
    v_mfma_f32_16x16x32_bf16 v[160:163], v[84:87], v[52:55], v[160:163]
    v_mfma_f32_16x16x32_bf16 v[164:167], v[88:91], v[52:55], v[164:167]
    v_mfma_f32_16x16x32_bf16 v[168:171], v[84:87], v[56:59], v[168:171]
    v_mfma_f32_16x16x32_bf16 v[172:175], v[88:91], v[56:59], v[172:175]
    v_mfma_f32_16x16x32_bf16 v[176:179], v[84:87], v[60:63], v[176:179]
    v_mfma_f32_16x16x32_bf16 v[180:183], v[88:91], v[60:63], v[180:183]
    v_mfma_f32_16x16x32_bf16 v[184:187], v[84:87], v[64:67], v[184:187]
    v_mfma_f32_16x16x32_bf16 v[188:191], v[88:91], v[64:67], v[188:191]
    s_nop 9
    v_add_f32 v164, 0x358637bd, v164
    v_rcp_f32 v164, v164
    v_add_f32 v172, 0x358637bd, v172
    v_rcp_f32 v172, v172
    v_add_f32 v180, 0x358637bd, v180
    v_rcp_f32 v180, v180
    v_add_f32 v188, 0x358637bd, v188
    v_rcp_f32 v188, v188
    s_nop 0
    v_mul_f32 v160, v160, v164
    v_mul_f32 v161, v161, v164
    v_mul_f32 v162, v162, v164
    v_mul_f32 v163, v163, v164
    v_cvt_pk_bf16_f32 v128, v160, v161
    v_cvt_pk_bf16_f32 v129, v162, v163
    v_mul_f32 v168, v168, v172
    v_mul_f32 v169, v169, v172
    v_mul_f32 v170, v170, v172
    v_mul_f32 v171, v171, v172
    v_cvt_pk_bf16_f32 v132, v168, v169
    v_cvt_pk_bf16_f32 v133, v170, v171
    v_mul_f32 v176, v176, v180
    v_mul_f32 v177, v177, v180
    v_mul_f32 v178, v178, v180
    v_mul_f32 v179, v179, v180
    v_cvt_pk_bf16_f32 v136, v176, v177
    v_cvt_pk_bf16_f32 v137, v178, v179
    v_mul_f32 v184, v184, v188
    v_mul_f32 v185, v185, v188
    v_mul_f32 v186, v186, v188
    v_mul_f32 v187, v187, v188
    v_cvt_pk_bf16_f32 v140, v184, v185
    v_cvt_pk_bf16_f32 v141, v186, v187
    v_cvt_pk_bf16_f32 v84, v36, v37
    v_cvt_pk_bf16_f32 v88, v44, v45
    v_cvt_pk_bf16_f32 v85, v38, v39
    v_cvt_pk_bf16_f32 v89, v46, v47
    v_cvt_pk_bf16_f32 v86, v40, v41
    v_cvt_pk_bf16_f32 v90, v48, v49
    v_cvt_pk_bf16_f32 v87, v42, v43
    v_cvt_pk_bf16_f32 v91, v50, v51
    v_mov_b32 v160, 0
    v_mov_b32 v161, 0
    v_mov_b32 v162, 0
    v_mov_b32 v163, 0
    v_mov_b32 v164, 0
    v_mov_b32 v165, 0
    v_mov_b32 v166, 0
    v_mov_b32 v167, 0
    v_mov_b32 v168, 0
    v_mov_b32 v169, 0
    v_mov_b32 v170, 0
    v_mov_b32 v171, 0
    v_mov_b32 v172, 0
    v_mov_b32 v173, 0
    v_mov_b32 v174, 0
    v_mov_b32 v175, 0
    v_mov_b32 v176, 0
    v_mov_b32 v177, 0
    v_mov_b32 v178, 0
    v_mov_b32 v179, 0
    v_mov_b32 v180, 0
    v_mov_b32 v181, 0
    v_mov_b32 v182, 0
    v_mov_b32 v183, 0
    v_mov_b32 v184, 0
    v_mov_b32 v185, 0
    v_mov_b32 v186, 0
    v_mov_b32 v187, 0
    v_mov_b32 v188, 0
    v_mov_b32 v189, 0
    v_mov_b32 v190, 0
    v_mov_b32 v191, 0
    s_nop 1
    v_mfma_f32_16x16x32_bf16 v[160:163], v[84:87], v[68:71], v[160:163]
    v_mfma_f32_16x16x32_bf16 v[164:167], v[88:91], v[68:71], v[164:167]
    v_mfma_f32_16x16x32_bf16 v[168:171], v[84:87], v[72:75], v[168:171]
    v_mfma_f32_16x16x32_bf16 v[172:175], v[88:91], v[72:75], v[172:175]
    v_mfma_f32_16x16x32_bf16 v[176:179], v[84:87], v[76:79], v[176:179]
    v_mfma_f32_16x16x32_bf16 v[180:183], v[88:91], v[76:79], v[180:183]
    v_mfma_f32_16x16x32_bf16 v[184:187], v[84:87], v[80:83], v[184:187]
    v_mfma_f32_16x16x32_bf16 v[188:191], v[88:91], v[80:83], v[188:191]
    s_nop 9
    v_add_f32 v164, 0x358637bd, v164
    v_rcp_f32 v164, v164
    v_add_f32 v172, 0x358637bd, v172
    v_rcp_f32 v172, v172
    v_add_f32 v180, 0x358637bd, v180
    v_rcp_f32 v180, v180
    v_add_f32 v188, 0x358637bd, v188
    v_rcp_f32 v188, v188
    s_nop 0
    v_mul_f32 v160, v160, v164
    v_mul_f32 v161, v161, v164
    v_mul_f32 v162, v162, v164
    v_mul_f32 v163, v163, v164
    v_cvt_pk_bf16_f32 v130, v160, v161
    v_cvt_pk_bf16_f32 v131, v162, v163
    v_mul_f32 v168, v168, v172
    v_mul_f32 v169, v169, v172
    v_mul_f32 v170, v170, v172
    v_mul_f32 v171, v171, v172
    v_cvt_pk_bf16_f32 v134, v168, v169
    v_cvt_pk_bf16_f32 v135, v170, v171
    v_mul_f32 v176, v176, v180
    v_mul_f32 v177, v177, v180
    v_mul_f32 v178, v178, v180
    v_mul_f32 v179, v179, v180
    v_cvt_pk_bf16_f32 v138, v176, v177
    v_cvt_pk_bf16_f32 v139, v178, v179
    v_mul_f32 v184, v184, v188
    v_mul_f32 v185, v185, v188
    v_mul_f32 v186, v186, v188
    v_mul_f32 v187, v187, v188
    v_cvt_pk_bf16_f32 v142, v184, v185
    v_cvt_pk_bf16_f32 v143, v186, v187
    ds_read_b64_tr_b16 v[144:145], v8 offset:8192
    ds_read_b64_tr_b16 v[146:147], v8 offset:10240
    ds_read_b64_tr_b16 v[148:149], v9 offset:8192
    ds_read_b64_tr_b16 v[150:151], v9 offset:10240
    ds_read_b64_tr_b16 v[152:153], v10 offset:8192
    ds_read_b64_tr_b16 v[154:155], v10 offset:10240
    ds_read_b64_tr_b16 v[156:157], v11 offset:8192
    ds_read_b64_tr_b16 v[158:159], v11 offset:10240
    s_waitcnt lgkmcnt(0)
    v_mfma_f32_16x16x32_bf16 v[192:195], v[144:147], v[128:131], v[192:195]
    v_mfma_f32_16x16x32_bf16 v[196:199], v[148:151], v[128:131], v[196:199]
    v_mfma_f32_16x16x32_bf16 v[200:203], v[152:155], v[128:131], v[200:203]
    v_mfma_f32_16x16x32_bf16 v[204:207], v[156:159], v[128:131], v[204:207]
    v_mfma_f32_16x16x32_bf16 v[208:211], v[144:147], v[132:135], v[208:211]
    v_mfma_f32_16x16x32_bf16 v[212:215], v[148:151], v[132:135], v[212:215]
    v_mfma_f32_16x16x32_bf16 v[216:219], v[152:155], v[132:135], v[216:219]
    v_mfma_f32_16x16x32_bf16 v[220:223], v[156:159], v[132:135], v[220:223]
    v_mfma_f32_16x16x32_bf16 v[224:227], v[144:147], v[136:139], v[224:227]
    v_mfma_f32_16x16x32_bf16 v[228:231], v[148:151], v[136:139], v[228:231]
    v_mfma_f32_16x16x32_bf16 v[232:235], v[152:155], v[136:139], v[232:235]
    v_mfma_f32_16x16x32_bf16 v[236:239], v[156:159], v[136:139], v[236:239]
    v_mfma_f32_16x16x32_bf16 v[240:243], v[144:147], v[140:143], v[240:243]
    v_mfma_f32_16x16x32_bf16 v[244:247], v[148:151], v[140:143], v[244:247]
    v_mfma_f32_16x16x32_bf16 v[248:251], v[152:155], v[140:143], v[248:251]
    v_mfma_f32_16x16x32_bf16 v[252:255], v[156:159], v[140:143], v[252:255]
    s_nop 1
    s_mul_i32 s20, s16, 7
    s_add_u32 s21, s20, 0
    s_lshl_b32 s31, s21, 15
    s_add_u32 s32, s8, s31
    s_addc_u32 s33, s9, 0
    global_load_dwordx4 v[160:163], v2, s[32:33]
    s_add_u32 s32, s32, 8192
    s_addc_u32 s33, s33, 0
    global_load_dwordx4 v[164:167], v2, s[32:33]
    s_add_u32 s32, s32, 8192
    s_addc_u32 s33, s33, 0
    global_load_dwordx4 v[168:171], v2, s[32:33]
    s_add_u32 s32, s32, 8192
    s_addc_u32 s33, s33, 0
    global_load_dwordx4 v[172:175], v2, s[32:33]
    s_add_u32 s32, s32, 8192
    s_addc_u32 s33, s33, 0
    s_add_u32 s26, s24, 0
    s_addc_u32 s27, s25, 0
    global_load_dwordx4 v[96:99], v3, s[26:27]
    s_add_u32 s26, s26, 57344
    s_addc_u32 s27, s27, 0
    global_load_dwordx4 v[100:103], v3, s[26:27]
    s_add_u32 s26, s26, 57344
    s_addc_u32 s27, s27, 0
    global_load_dwordx4 v[104:107], v3, s[26:27]
    s_add_u32 s26, s26, 57344
    s_addc_u32 s27, s27, 0
    global_load_dwordx4 v[108:111], v3, s[26:27]
    s_add_u32 s21, s20, 1
    s_lshl_b32 s31, s21, 15
    s_add_u32 s32, s8, s31
    s_addc_u32 s33, s9, 0
    global_load_dwordx4 v[176:179], v2, s[32:33]
    s_add_u32 s32, s32, 8192
    s_addc_u32 s33, s33, 0
    global_load_dwordx4 v[180:183], v2, s[32:33]
    s_add_u32 s32, s32, 8192
    s_addc_u32 s33, s33, 0
    global_load_dwordx4 v[184:187], v2, s[32:33]
    s_add_u32 s32, s32, 8192
    s_addc_u32 s33, s33, 0
    global_load_dwordx4 v[188:191], v2, s[32:33]
    s_add_u32 s32, s32, 8192
    s_addc_u32 s33, s33, 0
    s_add_u32 s26, s24, 1024
    s_addc_u32 s27, s25, 0
    global_load_dwordx4 v[112:115], v3, s[26:27]
    s_add_u32 s26, s26, 57344
    s_addc_u32 s27, s27, 0
    global_load_dwordx4 v[116:119], v3, s[26:27]
    s_add_u32 s26, s26, 57344
    s_addc_u32 s27, s27, 0
    global_load_dwordx4 v[120:123], v3, s[26:27]
    s_add_u32 s26, s26, 57344
    s_addc_u32 s27, s27, 0
    global_load_dwordx4 v[124:127], v3, s[26:27]
    v_add_u32 v19, s17, v3
    s_waitcnt vmcnt(8)
    ds_write_b128 v19, v[160:163] offset:0
    ds_write_b128 v19, v[164:167] offset:1024
    ds_write_b128 v19, v[168:171] offset:2048
    ds_write_b128 v19, v[172:175] offset:3072
    s_waitcnt lgkmcnt(0)
    s_add_u32 s21, s20, 2
    s_lshl_b32 s31, s21, 15
    s_add_u32 s32, s8, s31
    s_addc_u32 s33, s9, 0
    global_load_dwordx4 v[160:163], v2, s[32:33]
    s_add_u32 s32, s32, 8192
    s_addc_u32 s33, s33, 0
    global_load_dwordx4 v[164:167], v2, s[32:33]
    s_add_u32 s32, s32, 8192
    s_addc_u32 s33, s33, 0
    global_load_dwordx4 v[168:171], v2, s[32:33]
    s_add_u32 s32, s32, 8192
    s_addc_u32 s33, s33, 0
    global_load_dwordx4 v[172:175], v2, s[32:33]
    s_add_u32 s32, s32, 8192
    s_addc_u32 s33, s33, 0
    s_add_u32 s26, s24, 2048
    s_addc_u32 s27, s25, 0
    global_load_dwordx4 v[128:131], v3, s[26:27]
    s_add_u32 s26, s26, 57344
    s_addc_u32 s27, s27, 0
    global_load_dwordx4 v[132:135], v3, s[26:27]
    s_add_u32 s26, s26, 57344
    s_addc_u32 s27, s27, 0
    global_load_dwordx4 v[136:139], v3, s[26:27]
    s_add_u32 s26, s26, 57344
    s_addc_u32 s27, s27, 0
    global_load_dwordx4 v[140:143], v3, s[26:27]
    ds_read_b64_tr_b16 v[144:145], v8 offset:0
    ds_read_b64_tr_b16 v[146:147], v8 offset:2048
    ds_read_b64_tr_b16 v[148:149], v9 offset:0
    ds_read_b64_tr_b16 v[150:151], v9 offset:2048
    ds_read_b64_tr_b16 v[152:153], v10 offset:0
    ds_read_b64_tr_b16 v[154:155], v10 offset:2048
    ds_read_b64_tr_b16 v[156:157], v11 offset:0
    ds_read_b64_tr_b16 v[158:159], v11 offset:2048
    s_waitcnt lgkmcnt(0)
    v_mfma_f32_16x16x32_bf16 v[192:195], v[144:147], v[96:99], v[192:195]
    v_mfma_f32_16x16x32_bf16 v[196:199], v[148:151], v[96:99], v[196:199]
    v_mfma_f32_16x16x32_bf16 v[200:203], v[152:155], v[96:99], v[200:203]
    v_mfma_f32_16x16x32_bf16 v[204:207], v[156:159], v[96:99], v[204:207]
    v_mfma_f32_16x16x32_bf16 v[208:211], v[144:147], v[100:103], v[208:211]
    v_mfma_f32_16x16x32_bf16 v[212:215], v[148:151], v[100:103], v[212:215]
    v_mfma_f32_16x16x32_bf16 v[216:219], v[152:155], v[100:103], v[216:219]
    v_mfma_f32_16x16x32_bf16 v[220:223], v[156:159], v[100:103], v[220:223]
    v_mfma_f32_16x16x32_bf16 v[224:227], v[144:147], v[104:107], v[224:227]
    v_mfma_f32_16x16x32_bf16 v[228:231], v[148:151], v[104:107], v[228:231]
    v_mfma_f32_16x16x32_bf16 v[232:235], v[152:155], v[104:107], v[232:235]
    v_mfma_f32_16x16x32_bf16 v[236:239], v[156:159], v[104:107], v[236:239]
    v_mfma_f32_16x16x32_bf16 v[240:243], v[144:147], v[108:111], v[240:243]
    v_mfma_f32_16x16x32_bf16 v[244:247], v[148:151], v[108:111], v[244:247]
    v_mfma_f32_16x16x32_bf16 v[248:251], v[152:155], v[108:111], v[248:251]
    v_mfma_f32_16x16x32_bf16 v[252:255], v[156:159], v[108:111], v[252:255]
    s_waitcnt vmcnt(8)
    ds_write_b128 v19, v[176:179] offset:4096
    ds_write_b128 v19, v[180:183] offset:5120
    ds_write_b128 v19, v[184:187] offset:6144
    ds_write_b128 v19, v[188:191] offset:7168
    s_waitcnt lgkmcnt(0)
    s_add_u32 s21, s20, 3
    s_lshl_b32 s31, s21, 15
    s_add_u32 s32, s8, s31
    s_addc_u32 s33, s9, 0
    global_load_dwordx4 v[176:179], v2, s[32:33]
    s_add_u32 s32, s32, 8192
    s_addc_u32 s33, s33, 0
    global_load_dwordx4 v[180:183], v2, s[32:33]
    s_add_u32 s32, s32, 8192
    s_addc_u32 s33, s33, 0
    global_load_dwordx4 v[184:187], v2, s[32:33]
    s_add_u32 s32, s32, 8192
    s_addc_u32 s33, s33, 0
    global_load_dwordx4 v[188:191], v2, s[32:33]
    s_add_u32 s32, s32, 8192
    s_addc_u32 s33, s33, 0
    s_add_u32 s26, s24, 3072
    s_addc_u32 s27, s25, 0
    global_load_dwordx4 v[96:99], v3, s[26:27]
    s_add_u32 s26, s26, 57344
    s_addc_u32 s27, s27, 0
    global_load_dwordx4 v[100:103], v3, s[26:27]
    s_add_u32 s26, s26, 57344
    s_addc_u32 s27, s27, 0
    global_load_dwordx4 v[104:107], v3, s[26:27]
    s_add_u32 s26, s26, 57344
    s_addc_u32 s27, s27, 0
    global_load_dwordx4 v[108:111], v3, s[26:27]
    ds_read_b64_tr_b16 v[144:145], v8 offset:4096
    ds_read_b64_tr_b16 v[146:147], v8 offset:6144
    ds_read_b64_tr_b16 v[148:149], v9 offset:4096
    ds_read_b64_tr_b16 v[150:151], v9 offset:6144
    ds_read_b64_tr_b16 v[152:153], v10 offset:4096
    ds_read_b64_tr_b16 v[154:155], v10 offset:6144
    ds_read_b64_tr_b16 v[156:157], v11 offset:4096
    ds_read_b64_tr_b16 v[158:159], v11 offset:6144
    s_waitcnt lgkmcnt(0)
    v_mfma_f32_16x16x32_bf16 v[192:195], v[144:147], v[112:115], v[192:195]
    v_mfma_f32_16x16x32_bf16 v[196:199], v[148:151], v[112:115], v[196:199]
    v_mfma_f32_16x16x32_bf16 v[200:203], v[152:155], v[112:115], v[200:203]
    v_mfma_f32_16x16x32_bf16 v[204:207], v[156:159], v[112:115], v[204:207]
    v_mfma_f32_16x16x32_bf16 v[208:211], v[144:147], v[116:119], v[208:211]
    v_mfma_f32_16x16x32_bf16 v[212:215], v[148:151], v[116:119], v[212:215]
    v_mfma_f32_16x16x32_bf16 v[216:219], v[152:155], v[116:119], v[216:219]
    v_mfma_f32_16x16x32_bf16 v[220:223], v[156:159], v[116:119], v[220:223]
    v_mfma_f32_16x16x32_bf16 v[224:227], v[144:147], v[120:123], v[224:227]
    v_mfma_f32_16x16x32_bf16 v[228:231], v[148:151], v[120:123], v[228:231]
    v_mfma_f32_16x16x32_bf16 v[232:235], v[152:155], v[120:123], v[232:235]
    v_mfma_f32_16x16x32_bf16 v[236:239], v[156:159], v[120:123], v[236:239]
    v_mfma_f32_16x16x32_bf16 v[240:243], v[144:147], v[124:127], v[240:243]
    v_mfma_f32_16x16x32_bf16 v[244:247], v[148:151], v[124:127], v[244:247]
    v_mfma_f32_16x16x32_bf16 v[248:251], v[152:155], v[124:127], v[248:251]
    v_mfma_f32_16x16x32_bf16 v[252:255], v[156:159], v[124:127], v[252:255]
    s_waitcnt vmcnt(8)
    ds_write_b128 v19, v[160:163] offset:8192
    ds_write_b128 v19, v[164:167] offset:9216
    ds_write_b128 v19, v[168:171] offset:10240
    ds_write_b128 v19, v[172:175] offset:11264
    s_waitcnt lgkmcnt(0)
    s_add_u32 s21, s20, 4
    s_lshl_b32 s31, s21, 15
    s_add_u32 s32, s8, s31
    s_addc_u32 s33, s9, 0
    global_load_dwordx4 v[160:163], v2, s[32:33]
    s_add_u32 s32, s32, 8192
    s_addc_u32 s33, s33, 0
    global_load_dwordx4 v[164:167], v2, s[32:33]
    s_add_u32 s32, s32, 8192
    s_addc_u32 s33, s33, 0
    global_load_dwordx4 v[168:171], v2, s[32:33]
    s_add_u32 s32, s32, 8192
    s_addc_u32 s33, s33, 0
    global_load_dwordx4 v[172:175], v2, s[32:33]
    s_add_u32 s32, s32, 8192
    s_addc_u32 s33, s33, 0
    s_add_u32 s26, s24, 4096
    s_addc_u32 s27, s25, 0
    global_load_dwordx4 v[112:115], v3, s[26:27]
    s_add_u32 s26, s26, 57344
    s_addc_u32 s27, s27, 0
    global_load_dwordx4 v[116:119], v3, s[26:27]
    s_add_u32 s26, s26, 57344
    s_addc_u32 s27, s27, 0
    global_load_dwordx4 v[120:123], v3, s[26:27]
    s_add_u32 s26, s26, 57344
    s_addc_u32 s27, s27, 0
    global_load_dwordx4 v[124:127], v3, s[26:27]
    ds_read_b64_tr_b16 v[144:145], v8 offset:8192
    ds_read_b64_tr_b16 v[146:147], v8 offset:10240
    ds_read_b64_tr_b16 v[148:149], v9 offset:8192
    ds_read_b64_tr_b16 v[150:151], v9 offset:10240
    ds_read_b64_tr_b16 v[152:153], v10 offset:8192
    ds_read_b64_tr_b16 v[154:155], v10 offset:10240
    ds_read_b64_tr_b16 v[156:157], v11 offset:8192
    ds_read_b64_tr_b16 v[158:159], v11 offset:10240
    s_waitcnt lgkmcnt(0)
    v_mfma_f32_16x16x32_bf16 v[192:195], v[144:147], v[128:131], v[192:195]
    v_mfma_f32_16x16x32_bf16 v[196:199], v[148:151], v[128:131], v[196:199]
    v_mfma_f32_16x16x32_bf16 v[200:203], v[152:155], v[128:131], v[200:203]
    v_mfma_f32_16x16x32_bf16 v[204:207], v[156:159], v[128:131], v[204:207]
    v_mfma_f32_16x16x32_bf16 v[208:211], v[144:147], v[132:135], v[208:211]
    v_mfma_f32_16x16x32_bf16 v[212:215], v[148:151], v[132:135], v[212:215]
    v_mfma_f32_16x16x32_bf16 v[216:219], v[152:155], v[132:135], v[216:219]
    v_mfma_f32_16x16x32_bf16 v[220:223], v[156:159], v[132:135], v[220:223]
    v_mfma_f32_16x16x32_bf16 v[224:227], v[144:147], v[136:139], v[224:227]
    v_mfma_f32_16x16x32_bf16 v[228:231], v[148:151], v[136:139], v[228:231]
    v_mfma_f32_16x16x32_bf16 v[232:235], v[152:155], v[136:139], v[232:235]
    v_mfma_f32_16x16x32_bf16 v[236:239], v[156:159], v[136:139], v[236:239]
    v_mfma_f32_16x16x32_bf16 v[240:243], v[144:147], v[140:143], v[240:243]
    v_mfma_f32_16x16x32_bf16 v[244:247], v[148:151], v[140:143], v[244:247]
    v_mfma_f32_16x16x32_bf16 v[248:251], v[152:155], v[140:143], v[248:251]
    v_mfma_f32_16x16x32_bf16 v[252:255], v[156:159], v[140:143], v[252:255]
    s_waitcnt vmcnt(8)
    ds_write_b128 v19, v[176:179] offset:0
    ds_write_b128 v19, v[180:183] offset:1024
    ds_write_b128 v19, v[184:187] offset:2048
    ds_write_b128 v19, v[188:191] offset:3072
    s_waitcnt lgkmcnt(0)
    s_add_u32 s21, s20, 5
    s_lshl_b32 s31, s21, 15
    s_add_u32 s32, s8, s31
    s_addc_u32 s33, s9, 0
    global_load_dwordx4 v[176:179], v2, s[32:33]
    s_add_u32 s32, s32, 8192
    s_addc_u32 s33, s33, 0
    global_load_dwordx4 v[180:183], v2, s[32:33]
    s_add_u32 s32, s32, 8192
    s_addc_u32 s33, s33, 0
    global_load_dwordx4 v[184:187], v2, s[32:33]
    s_add_u32 s32, s32, 8192
    s_addc_u32 s33, s33, 0
    global_load_dwordx4 v[188:191], v2, s[32:33]
    s_add_u32 s32, s32, 8192
    s_addc_u32 s33, s33, 0
    s_add_u32 s26, s24, 5120
    s_addc_u32 s27, s25, 0
    global_load_dwordx4 v[128:131], v3, s[26:27]
    s_add_u32 s26, s26, 57344
    s_addc_u32 s27, s27, 0
    global_load_dwordx4 v[132:135], v3, s[26:27]
    s_add_u32 s26, s26, 57344
    s_addc_u32 s27, s27, 0
    global_load_dwordx4 v[136:139], v3, s[26:27]
    s_add_u32 s26, s26, 57344
    s_addc_u32 s27, s27, 0
    global_load_dwordx4 v[140:143], v3, s[26:27]
    ds_read_b64_tr_b16 v[144:145], v8 offset:0
    ds_read_b64_tr_b16 v[146:147], v8 offset:2048
    ds_read_b64_tr_b16 v[148:149], v9 offset:0
    ds_read_b64_tr_b16 v[150:151], v9 offset:2048
    ds_read_b64_tr_b16 v[152:153], v10 offset:0
    ds_read_b64_tr_b16 v[154:155], v10 offset:2048
    ds_read_b64_tr_b16 v[156:157], v11 offset:0
    ds_read_b64_tr_b16 v[158:159], v11 offset:2048
    s_waitcnt lgkmcnt(0)
    v_mfma_f32_16x16x32_bf16 v[192:195], v[144:147], v[96:99], v[192:195]
    v_mfma_f32_16x16x32_bf16 v[196:199], v[148:151], v[96:99], v[196:199]
    v_mfma_f32_16x16x32_bf16 v[200:203], v[152:155], v[96:99], v[200:203]
    v_mfma_f32_16x16x32_bf16 v[204:207], v[156:159], v[96:99], v[204:207]
    v_mfma_f32_16x16x32_bf16 v[208:211], v[144:147], v[100:103], v[208:211]
    v_mfma_f32_16x16x32_bf16 v[212:215], v[148:151], v[100:103], v[212:215]
    v_mfma_f32_16x16x32_bf16 v[216:219], v[152:155], v[100:103], v[216:219]
    v_mfma_f32_16x16x32_bf16 v[220:223], v[156:159], v[100:103], v[220:223]
    v_mfma_f32_16x16x32_bf16 v[224:227], v[144:147], v[104:107], v[224:227]
    v_mfma_f32_16x16x32_bf16 v[228:231], v[148:151], v[104:107], v[228:231]
    v_mfma_f32_16x16x32_bf16 v[232:235], v[152:155], v[104:107], v[232:235]
    v_mfma_f32_16x16x32_bf16 v[236:239], v[156:159], v[104:107], v[236:239]
    v_mfma_f32_16x16x32_bf16 v[240:243], v[144:147], v[108:111], v[240:243]
    v_mfma_f32_16x16x32_bf16 v[244:247], v[148:151], v[108:111], v[244:247]
    v_mfma_f32_16x16x32_bf16 v[248:251], v[152:155], v[108:111], v[248:251]
    v_mfma_f32_16x16x32_bf16 v[252:255], v[156:159], v[108:111], v[252:255]
    s_waitcnt vmcnt(8)
    ds_write_b128 v19, v[160:163] offset:4096
    ds_write_b128 v19, v[164:167] offset:5120
    ds_write_b128 v19, v[168:171] offset:6144
    ds_write_b128 v19, v[172:175] offset:7168
    s_waitcnt lgkmcnt(0)
    s_add_u32 s21, s20, 6
    s_lshl_b32 s31, s21, 15
    s_add_u32 s32, s8, s31
    s_addc_u32 s33, s9, 0
    global_load_dwordx4 v[160:163], v2, s[32:33]
    s_add_u32 s32, s32, 8192
    s_addc_u32 s33, s33, 0
    global_load_dwordx4 v[164:167], v2, s[32:33]
    s_add_u32 s32, s32, 8192
    s_addc_u32 s33, s33, 0
    global_load_dwordx4 v[168:171], v2, s[32:33]
    s_add_u32 s32, s32, 8192
    s_addc_u32 s33, s33, 0
    global_load_dwordx4 v[172:175], v2, s[32:33]
    s_add_u32 s32, s32, 8192
    s_addc_u32 s33, s33, 0
    s_add_u32 s26, s24, 6144
    s_addc_u32 s27, s25, 0
    global_load_dwordx4 v[96:99], v3, s[26:27]
    s_add_u32 s26, s26, 57344
    s_addc_u32 s27, s27, 0
    global_load_dwordx4 v[100:103], v3, s[26:27]
    s_add_u32 s26, s26, 57344
    s_addc_u32 s27, s27, 0
    global_load_dwordx4 v[104:107], v3, s[26:27]
    s_add_u32 s26, s26, 57344
    s_addc_u32 s27, s27, 0
    global_load_dwordx4 v[108:111], v3, s[26:27]
    ds_read_b64_tr_b16 v[144:145], v8 offset:4096
    ds_read_b64_tr_b16 v[146:147], v8 offset:6144
    ds_read_b64_tr_b16 v[148:149], v9 offset:4096
    ds_read_b64_tr_b16 v[150:151], v9 offset:6144
    ds_read_b64_tr_b16 v[152:153], v10 offset:4096
    ds_read_b64_tr_b16 v[154:155], v10 offset:6144
    ds_read_b64_tr_b16 v[156:157], v11 offset:4096
    ds_read_b64_tr_b16 v[158:159], v11 offset:6144
    s_waitcnt lgkmcnt(0)
    v_mfma_f32_16x16x32_bf16 v[192:195], v[144:147], v[112:115], v[192:195]
    v_mfma_f32_16x16x32_bf16 v[196:199], v[148:151], v[112:115], v[196:199]
    v_mfma_f32_16x16x32_bf16 v[200:203], v[152:155], v[112:115], v[200:203]
    v_mfma_f32_16x16x32_bf16 v[204:207], v[156:159], v[112:115], v[204:207]
    v_mfma_f32_16x16x32_bf16 v[208:211], v[144:147], v[116:119], v[208:211]
    v_mfma_f32_16x16x32_bf16 v[212:215], v[148:151], v[116:119], v[212:215]
    v_mfma_f32_16x16x32_bf16 v[216:219], v[152:155], v[116:119], v[216:219]
    v_mfma_f32_16x16x32_bf16 v[220:223], v[156:159], v[116:119], v[220:223]
    v_mfma_f32_16x16x32_bf16 v[224:227], v[144:147], v[120:123], v[224:227]
    v_mfma_f32_16x16x32_bf16 v[228:231], v[148:151], v[120:123], v[228:231]
    v_mfma_f32_16x16x32_bf16 v[232:235], v[152:155], v[120:123], v[232:235]
    v_mfma_f32_16x16x32_bf16 v[236:239], v[156:159], v[120:123], v[236:239]
    v_mfma_f32_16x16x32_bf16 v[240:243], v[144:147], v[124:127], v[240:243]
    v_mfma_f32_16x16x32_bf16 v[244:247], v[148:151], v[124:127], v[244:247]
    v_mfma_f32_16x16x32_bf16 v[248:251], v[152:155], v[124:127], v[248:251]
    v_mfma_f32_16x16x32_bf16 v[252:255], v[156:159], v[124:127], v[252:255]
    s_waitcnt vmcnt(8)
    ds_write_b128 v19, v[176:179] offset:8192
    ds_write_b128 v19, v[180:183] offset:9216
    ds_write_b128 v19, v[184:187] offset:10240
    ds_write_b128 v19, v[188:191] offset:11264
    s_waitcnt lgkmcnt(0)
    ds_read_b64_tr_b16 v[144:145], v8 offset:8192
    ds_read_b64_tr_b16 v[146:147], v8 offset:10240
    ds_read_b64_tr_b16 v[148:149], v9 offset:8192
    ds_read_b64_tr_b16 v[150:151], v9 offset:10240
    ds_read_b64_tr_b16 v[152:153], v10 offset:8192
    ds_read_b64_tr_b16 v[154:155], v10 offset:10240
    ds_read_b64_tr_b16 v[156:157], v11 offset:8192
    ds_read_b64_tr_b16 v[158:159], v11 offset:10240
    s_waitcnt lgkmcnt(0)
    v_mfma_f32_16x16x32_bf16 v[192:195], v[144:147], v[128:131], v[192:195]
    v_mfma_f32_16x16x32_bf16 v[196:199], v[148:151], v[128:131], v[196:199]
    v_mfma_f32_16x16x32_bf16 v[200:203], v[152:155], v[128:131], v[200:203]
    v_mfma_f32_16x16x32_bf16 v[204:207], v[156:159], v[128:131], v[204:207]
    v_mfma_f32_16x16x32_bf16 v[208:211], v[144:147], v[132:135], v[208:211]
    v_mfma_f32_16x16x32_bf16 v[212:215], v[148:151], v[132:135], v[212:215]
    v_mfma_f32_16x16x32_bf16 v[216:219], v[152:155], v[132:135], v[216:219]
    v_mfma_f32_16x16x32_bf16 v[220:223], v[156:159], v[132:135], v[220:223]
    v_mfma_f32_16x16x32_bf16 v[224:227], v[144:147], v[136:139], v[224:227]
    v_mfma_f32_16x16x32_bf16 v[228:231], v[148:151], v[136:139], v[228:231]
    v_mfma_f32_16x16x32_bf16 v[232:235], v[152:155], v[136:139], v[232:235]
    v_mfma_f32_16x16x32_bf16 v[236:239], v[156:159], v[136:139], v[236:239]
    v_mfma_f32_16x16x32_bf16 v[240:243], v[144:147], v[140:143], v[240:243]
    v_mfma_f32_16x16x32_bf16 v[244:247], v[148:151], v[140:143], v[244:247]
    v_mfma_f32_16x16x32_bf16 v[248:251], v[152:155], v[140:143], v[248:251]
    v_mfma_f32_16x16x32_bf16 v[252:255], v[156:159], v[140:143], v[252:255]
    s_waitcnt vmcnt(0)
    ds_write_b128 v19, v[160:163] offset:0
    ds_write_b128 v19, v[164:167] offset:1024
    ds_write_b128 v19, v[168:171] offset:2048
    ds_write_b128 v19, v[172:175] offset:3072
    s_waitcnt lgkmcnt(0)
    ds_read_b64_tr_b16 v[144:145], v8 offset:0
    ds_read_b64_tr_b16 v[146:147], v8 offset:2048
    ds_read_b64_tr_b16 v[148:149], v9 offset:0
    ds_read_b64_tr_b16 v[150:151], v9 offset:2048
    ds_read_b64_tr_b16 v[152:153], v10 offset:0
    ds_read_b64_tr_b16 v[154:155], v10 offset:2048
    ds_read_b64_tr_b16 v[156:157], v11 offset:0
    ds_read_b64_tr_b16 v[158:159], v11 offset:2048
    s_waitcnt lgkmcnt(0)
    v_mfma_f32_16x16x32_bf16 v[192:195], v[144:147], v[96:99], v[192:195]
    v_mfma_f32_16x16x32_bf16 v[196:199], v[148:151], v[96:99], v[196:199]
    v_mfma_f32_16x16x32_bf16 v[200:203], v[152:155], v[96:99], v[200:203]
    v_mfma_f32_16x16x32_bf16 v[204:207], v[156:159], v[96:99], v[204:207]
    v_mfma_f32_16x16x32_bf16 v[208:211], v[144:147], v[100:103], v[208:211]
    v_mfma_f32_16x16x32_bf16 v[212:215], v[148:151], v[100:103], v[212:215]
    v_mfma_f32_16x16x32_bf16 v[216:219], v[152:155], v[100:103], v[216:219]
    v_mfma_f32_16x16x32_bf16 v[220:223], v[156:159], v[100:103], v[220:223]
    v_mfma_f32_16x16x32_bf16 v[224:227], v[144:147], v[104:107], v[224:227]
    v_mfma_f32_16x16x32_bf16 v[228:231], v[148:151], v[104:107], v[228:231]
    v_mfma_f32_16x16x32_bf16 v[232:235], v[152:155], v[104:107], v[232:235]
    v_mfma_f32_16x16x32_bf16 v[236:239], v[156:159], v[104:107], v[236:239]
    v_mfma_f32_16x16x32_bf16 v[240:243], v[144:147], v[108:111], v[240:243]
    v_mfma_f32_16x16x32_bf16 v[244:247], v[148:151], v[108:111], v[244:247]
    v_mfma_f32_16x16x32_bf16 v[248:251], v[152:155], v[108:111], v[248:251]
    v_mfma_f32_16x16x32_bf16 v[252:255], v[156:159], v[108:111], v[252:255]
    s_nop 11
    s_barrier
    s_lshl_b32 s31, s16, 14
    v_add_u32 v5, s31, v3
    ds_write_b128 v5, v[192:195] offset:0
    ds_write_b128 v5, v[196:199] offset:1024
    ds_write_b128 v5, v[200:203] offset:2048
    ds_write_b128 v5, v[204:207] offset:3072
    ds_write_b128 v5, v[208:211] offset:4096
    ds_write_b128 v5, v[212:215] offset:5120
    ds_write_b128 v5, v[216:219] offset:6144
    ds_write_b128 v5, v[220:223] offset:7168
    ds_write_b128 v5, v[224:227] offset:8192
    ds_write_b128 v5, v[228:231] offset:9216
    ds_write_b128 v5, v[232:235] offset:10240
    ds_write_b128 v5, v[236:239] offset:11264
    ds_write_b128 v5, v[240:243] offset:12288
    ds_write_b128 v5, v[244:247] offset:13312
    ds_write_b128 v5, v[248:251] offset:14336
    ds_write_b128 v5, v[252:255] offset:15360
    s_waitcnt lgkmcnt(0)
    s_barrier
    s_lshl_b32 s31, s16, 11
    v_add_u32 v5, s31, v3
    v_add_u32 v15, 0x10000, v5
    ds_read_b128 v[20:23], v5 offset:0
    ds_read_b128 v[24:27], v5 offset:16384
    ds_read_b128 v[28:31], v5 offset:32768
    ds_read_b128 v[32:35], v5 offset:49152
    ds_read_b128 v[36:39], v15 offset:0
    ds_read_b128 v[40:43], v15 offset:16384
    ds_read_b128 v[44:47], v15 offset:32768
    ds_read_b128 v[48:51], v15 offset:49152
    s_waitcnt lgkmcnt(0)
    v_add_f32 v20, v20, v24
    v_add_f32 v21, v21, v25
    v_add_f32 v22, v22, v26
    v_add_f32 v23, v23, v27
    v_add_f32 v20, v20, v28
    v_add_f32 v21, v21, v29
    v_add_f32 v22, v22, v30
    v_add_f32 v23, v23, v31
    v_add_f32 v20, v20, v32
    v_add_f32 v21, v21, v33
    v_add_f32 v22, v22, v34
    v_add_f32 v23, v23, v35
    v_add_f32 v20, v20, v36
    v_add_f32 v21, v21, v37
    v_add_f32 v22, v22, v38
    v_add_f32 v23, v23, v39
    v_add_f32 v20, v20, v40
    v_add_f32 v21, v21, v41
    v_add_f32 v22, v22, v42
    v_add_f32 v23, v23, v43
    v_add_f32 v20, v20, v44
    v_add_f32 v21, v21, v45
    v_add_f32 v22, v22, v46
    v_add_f32 v23, v23, v47
    v_add_f32 v20, v20, v48
    v_add_f32 v21, v21, v49
    v_add_f32 v22, v22, v50
    v_add_f32 v23, v23, v51
    s_lshr_b32 s31, s16, 1
    s_lshl_b32 s31, s31, 4
    s_lshl_b32 s34, s14, 6
    s_add_u32 s31, s31, s34
    v_and_b32 v6, 15, v1
    v_add_u32 v6, s31, v6
    v_lshlrev_b32 v6, 10, v6
    s_and_b32 s31, s16, 1
    s_lshl_b32 s31, s31, 6
    s_add_u32 s31, s31, 0
    s_lshl_b32 s34, s15, 7
    s_add_u32 s31, s31, s34
    v_lshrrev_b32 v7, 4, v1
    v_lshl_add_u32 v6, v7, 3, v6
    v_add_u32 v6, s31, v6
    global_load_dwordx2 v[60:61], v6, s[4:5]
    s_waitcnt vmcnt(0)
    v_lshlrev_b32 v62, 16, v60
    v_and_b32 v63, 0xffff0000, v60
    v_add_f32 v20, v20, v62
    v_add_f32 v21, v21, v63
    v_lshlrev_b32 v62, 16, v61
    v_and_b32 v63, 0xffff0000, v61
    v_add_f32 v22, v22, v62
    v_add_f32 v23, v23, v63
    v_cvt_pk_bf16_f32 v60, v20, v21
    v_cvt_pk_bf16_f32 v61, v22, v23
    global_store_dwordx2 v6, v[60:61], s[10:11]
    ds_read_b128 v[20:23], v5 offset:1024
    ds_read_b128 v[24:27], v5 offset:17408
    ds_read_b128 v[28:31], v5 offset:33792
    ds_read_b128 v[32:35], v5 offset:50176
    ds_read_b128 v[36:39], v15 offset:1024
    ds_read_b128 v[40:43], v15 offset:17408
    ds_read_b128 v[44:47], v15 offset:33792
    ds_read_b128 v[48:51], v15 offset:50176
    s_waitcnt lgkmcnt(0)
    v_add_f32 v20, v20, v24
    v_add_f32 v21, v21, v25
    v_add_f32 v22, v22, v26
    v_add_f32 v23, v23, v27
    v_add_f32 v20, v20, v28
    v_add_f32 v21, v21, v29
    v_add_f32 v22, v22, v30
    v_add_f32 v23, v23, v31
    v_add_f32 v20, v20, v32
    v_add_f32 v21, v21, v33
    v_add_f32 v22, v22, v34
    v_add_f32 v23, v23, v35
    v_add_f32 v20, v20, v36
    v_add_f32 v21, v21, v37
    v_add_f32 v22, v22, v38
    v_add_f32 v23, v23, v39
    v_add_f32 v20, v20, v40
    v_add_f32 v21, v21, v41
    v_add_f32 v22, v22, v42
    v_add_f32 v23, v23, v43
    v_add_f32 v20, v20, v44
    v_add_f32 v21, v21, v45
    v_add_f32 v22, v22, v46
    v_add_f32 v23, v23, v47
    v_add_f32 v20, v20, v48
    v_add_f32 v21, v21, v49
    v_add_f32 v22, v22, v50
    v_add_f32 v23, v23, v51
    s_lshr_b32 s31, s16, 1
    s_lshl_b32 s31, s31, 4
    s_lshl_b32 s34, s14, 6
    s_add_u32 s31, s31, s34
    v_and_b32 v6, 15, v1
    v_add_u32 v6, s31, v6
    v_lshlrev_b32 v6, 10, v6
    s_and_b32 s31, s16, 1
    s_lshl_b32 s31, s31, 6
    s_add_u32 s31, s31, 32
    s_lshl_b32 s34, s15, 7
    s_add_u32 s31, s31, s34
    v_lshrrev_b32 v7, 4, v1
    v_lshl_add_u32 v6, v7, 3, v6
    v_add_u32 v6, s31, v6
    global_load_dwordx2 v[60:61], v6, s[4:5]
    s_waitcnt vmcnt(0)
    v_lshlrev_b32 v62, 16, v60
    v_and_b32 v63, 0xffff0000, v60
    v_add_f32 v20, v20, v62
    v_add_f32 v21, v21, v63
    v_lshlrev_b32 v62, 16, v61
    v_and_b32 v63, 0xffff0000, v61
    v_add_f32 v22, v22, v62
    v_add_f32 v23, v23, v63
    v_cvt_pk_bf16_f32 v60, v20, v21
    v_cvt_pk_bf16_f32 v61, v22, v23
    global_store_dwordx2 v6, v[60:61], s[10:11]
L2_end:
    s_endpgm
.section .rodata,"a"
.p2align 6
.amdhsa_kernel ln_kernel
  .amdhsa_next_free_vgpr 32
  .amdhsa_next_free_sgpr 32
  .amdhsa_accum_offset 32
  .amdhsa_group_segment_fixed_size 0
  .amdhsa_kernarg_size 88
  .amdhsa_user_sgpr_count 2
  .amdhsa_user_sgpr_kernarg_segment_ptr 1
  .amdhsa_system_sgpr_workgroup_id_x 1
.end_amdhsa_kernel
.amdhsa_kernel gemm1_kernel
  .amdhsa_next_free_vgpr 256
  .amdhsa_next_free_sgpr 102
  .amdhsa_accum_offset 256
  .amdhsa_group_segment_fixed_size 0
  .amdhsa_kernarg_size 88
  .amdhsa_user_sgpr_count 2
  .amdhsa_user_sgpr_kernarg_segment_ptr 1
  .amdhsa_system_sgpr_workgroup_id_x 1
.end_amdhsa_kernel
.amdhsa_kernel gemm2_kernel
  .amdhsa_next_free_vgpr 256
  .amdhsa_next_free_sgpr 102
  .amdhsa_accum_offset 256
  .amdhsa_group_segment_fixed_size 0
  .amdhsa_kernarg_size 88
  .amdhsa_user_sgpr_count 2
  .amdhsa_user_sgpr_kernarg_segment_ptr 1
  .amdhsa_system_sgpr_workgroup_id_x 1
.end_amdhsa_kernel
```
